```python
import torch

def _softmax(x, axis=-1):
    return torch.softmax(x, dim=axis)

def _gelu(x):
    return torch.nn.functional.gelu(x, approximate='tanh')

def _silu(x):
    return torch.nn.functional.silu(x)

def _sigmoid(x):
    return torch.sigmoid(x)

def _layernorm(x, axis=-1, eps=1e-05):
    m = x.mean(dim=axis, keepdim=True)
    v = x.var(dim=axis, keepdim=True, unbiased=False)
    return (x - m) / torch.sqrt(v + eps)

def _scatter_add(tgt, idx, src, axis=0):
    return tgt.clone().index_add_(axis, idx, src)

def _segment_sum(src, seg, n):
    out = torch.zeros((n,) + src.shape[1:], dtype=src.dtype)
    return out.index_add_(0, seg, src)

def _pad(x, pw):
    flat = tuple((v for pair in reversed(pw) for v in pair))
    return torch.nn.functional.pad(x, flat)
kernel_name = 'recurrent_scan__ssm_conv_h3__mixer_gmlp__prompt'

def setup_inputs():

    _w = lambda a: (lambda t: t.to(torch.bfloat16) if t.is_floating_point() else t)(torch.as_tensor(a))

    def _A_setup():
        B, S, D = (1, 2048, 448)
        ks = 4
        return {'q': _w((lambda *s: torch.randn(*s, dtype=torch.bfloat16) * 0.05)(B, S, D)), 'k': _w((lambda *s: torch.randn(*s, dtype=torch.bfloat16) * 0.2)(B, S, D)), 'v': _w((lambda *s: torch.randn(*s, dtype=torch.bfloat16) * 0.2)(B, S, D)), 'shift_k': _w((lambda *s: torch.randn(*s, dtype=torch.bfloat16) * 0.2)(D, ks) * 0.5), 'ssm_k': _w((lambda *s: torch.randn(*s, dtype=torch.bfloat16) * 0.2)(D, S) * (1.0 / S ** 0.5)), 'ssm_D': _w((lambda *s: torch.randn(*s, dtype=torch.bfloat16) * 0.2)(D))}
    _A_in = _A_setup()

    def _B_setup():
        B, S, D, F = (1, 2048, 448, 1792)
        Fh = F // 2
        return {'x': _w((lambda *s: torch.randn(*s, dtype=torch.bfloat16) * 0.05)(B, S, D)), 'w_in': _w((lambda *s: torch.randn(*s, dtype=torch.bfloat16) * 0.8)(D, 2 * Fh)), 'w_sp': _w(0.01 * (lambda *s: torch.randn(*s, dtype=torch.bfloat16) * 0.8)(S, S)), 'b_sp': _w(1.0 + 0.01 * (lambda *s: torch.randn(*s, dtype=torch.bfloat16) * 0.1)(S)), 'w_out': _w((lambda *s: torch.randn(*s, dtype=torch.bfloat16) * 0.1)(Fh, D))}
    _B_in = _B_setup()
    return {'A_q': _A_in['q'], 'A_k': _A_in['k'], 'A_v': _A_in['v'], 'A_shift_k': _A_in['shift_k'], 'A_ssm_k': _A_in['ssm_k'], 'A_ssm_D': _A_in['ssm_D'], 'B_x': _B_in['x'], 'B_w_in': _B_in['w_in'], 'B_w_sp': _B_in['w_sp'], 'B_b_sp': _B_in['b_sp'], 'B_w_out': _B_in['w_out']}

def reference(A_q, A_k, A_v, A_shift_k, A_ssm_k, A_ssm_D, B_x, B_w_in, B_w_sp, B_b_sp, B_w_out):

    def _A_ref(q, k, v, shift_k, ssm_k, ssm_D):
        B, S, D = q.shape
        ks = shift_k.shape[-1]
        k_pad = _pad(k, ((0, 0), (ks - 1, 0), (0, 0)))
        k_shift = torch.zeros_like(k)
        for t in range(ks):
            k_shift = k_shift + k_pad[:, t:t + S, :] * shift_k[:, ks - 1 - t][None, None, :]
        kv = k_shift * v
        L = 2 * S
        kv_pad = _pad(kv, ((0, 0), (0, S), (0, 0)))
        kf_pad = _pad(ssm_k, ((0, 0), (0, S)))
        kv_f = (lambda x, axes=(-2, -1): torch.fft.rfft2(x.float(), dim=axes))(kv_pad[:, None, :, :], axes=(1, 2))
        kf_f = (lambda x, axes=(-2, -1): torch.fft.rfft2(x.float(), dim=axes))(kf_pad[:, None, :], axes=(1, 2))
        kf_f = (lambda x, *d: x.permute(*d))(kf_f, 1, 2, 0)
        y_f = kv_f * kf_f[None, :, :, :]
        y = (lambda x, s, axes=(-2, -1): torch.fft.irfft2(x, s=s, dim=axes).to(torch.bfloat16))(y_f, (1, L), axes=(1, 2))[:, 0, :S, :]
        y = y + kv * ssm_D[None, None, :]
        return q * y

    def _B_ref(x, w_in, w_sp, b_sp, w_out):
        B, S, D = x.shape
        F = w_in.shape[-1]
        Fh = F // 2
        z = _gelu(torch.einsum('bsd,df->bsf', x, w_in))
        z1 = z[..., :Fh].clone()
        z2 = _layernorm(z[..., Fh:], axis=-1)
        g = torch.einsum('ts,bsf->btf', w_sp, z2) + b_sp[None, :, None]
        return torch.einsum('bsf,fd->bsd', z1 * g, w_out)
    x = A_q
    xn = _layernorm(x, axis=-1)
    s = _A_ref(xn, A_k, A_v, A_shift_k, A_ssm_k, A_ssm_D)
    g = _silu(_B_ref(xn, B_w_in, B_w_sp, B_b_sp, B_w_out))
    return x + s * g
```

```asm
; @launch grid=(256,1,1) block=(512,1,1) lds=163840
.amdgcn_target "amdgcn-amd-amdhsa--gfx950"
.text
.globl recurrent_scan__ssm_conv_h3__mixer_gmlp__prompt_kernel
.p2align 8
.type recurrent_scan__ssm_conv_h3__mixer_gmlp__prompt_kernel,@function
recurrent_scan__ssm_conv_h3__mixer_gmlp__prompt_kernel:
    s_cmp_ge_u32 s2, 256
    s_cbranch_scc1 recurrent_scan__ssm_conv_h3__mixer_gmlp__prompt_kernel_end
    s_load_dwordx8 s[64:71], s[0:1], 0
    s_load_dwordx4 s[72:75], s[0:1], 56
    s_load_dwordx4 s[76:79], s[0:1], 96
    s_load_dwordx2 s[48:49], s[0:1], 80
    s_getpc_b64 s[40:41]
recurrent_scan__ssm_conv_h3__mixer_gmlp__prompt_kernel_pc:
    s_sub_u32 s40, s40, recurrent_scan__ssm_conv_h3__mixer_gmlp__prompt_kernel_pc-recurrent_scan__ssm_conv_h3__mixer_gmlp__prompt_kernel
    s_subb_u32 s41, s41, 0
    s_lshr_b32 s3, s2, 3
    s_lshl_b32 s3, s3, 10
    v_lshl_add_u32 v1, v0, 1, s3
    s_mov_b64 exec, 1
    global_load_dword v255, v1, s[40:41]
    s_mov_b64 exec, -1
    v_lshrrev_b32 v1, 6, v0
    v_and_b32 v2, 31, v0
    v_readfirstlane_b32 s30, v1
    v_and_b32 v1, 63, v0
    v_lshrrev_b32 v3, 5, v1
    s_and_b32 s31, s30, 3
    s_lshr_b32 s32, s30, 2
    s_and_b32 s35, s2, 7
    s_lshr_b32 s3, s2, 3
    v_and_b32 v28, 15, v0
    v_lshlrev_b32 v28, 2, v28
    v_add_u32 v28, 163328, v28
    v_mov_b32 v29, 0
    ds_write_b32 v28, v29
    s_cmp_ge_u32 s3, 28
    s_cbranch_scc1 recurrent_scan__ssm_conv_h3__mixer_gmlp__prompt_kernel_aux
    s_mul_i32 s33, s3, 37
    s_lshr_b32 s33, s33, 8
    s_mul_i32 s34, s33, 7
    s_sub_u32 s34, s3, s34
    s_lshl_b32 s4, s33, 1
    s_add_u32 s4, s4, s34
    s_add_u32 s4, s4, s35
    s_and_b32 s7, s35, 3
    s_lshl_b32 s7, s7, 2
    s_add_u32 s33, s33, s7
    s_lshr_b32 s7, s35, 2
    s_mul_i32 s7, s7, 7
    s_add_u32 s34, s34, s7
    v_lshrrev_b32 v28, 3, v1
    v_lshrrev_b32 v29, 4, v1
    v_xor_b32 v30, v29, v1
    v_and_b32 v30, 7, v30
    v_mul_u32_u24 v7, 896, v28
    v_lshl_add_u32 v4, v30, 4, v7
    v_xor_b32 v30, 4, v30
    v_lshl_add_u32 v5, v30, 4, v7
    v_add_u32 v5, 7168, v5
    v_and_b32 v29, 1, v29
    v_lshlrev_b32 v29, 2, v29
    v_xor_b32 v30, v29, v1
    v_and_b32 v30, 7, v30
    v_mul_u32_u24 v6, 3584, v28
    v_lshl_add_u32 v6, v30, 4, v6
    s_mul_i32 s44, s30, 28672
    s_add_u32 s44, s44, 1792
    v_add_u32 v126, s44, v6
    s_lshl_b32 s7, s33, 7
    s_lshl_b32 s5, s30, 4
    s_add_u32 s7, s7, s5
    s_mul_i32 s6, s7, 896
    s_lshl_b32 s44, s34, 7
    s_lshl_b32 s61, s30, 11
    s_lshl_b32 s45, s30, 10
    s_cmp_ge_u32 s4, 7
    s_cselect_b32 s5, 7, 0
    s_sub_u32 s4, s4, s5
    s_cmp_ge_u32 s4, 7
    s_cselect_b32 s5, 7, 0
    s_sub_u32 s4, s4, s5
    s_lshl_b32 s5, s4, 7
    s_add_u32 s16, s5, s6
    s_mul_i32 s5, s4, 229376
    s_add_u32 s23, s5, s44
    s_add_u32 s4, s4, 1
    s_cmp_eq_u32 s4, 7
    s_cselect_b32 s4, 0, s4
    s_waitcnt lgkmcnt(0)
    s_mov_b32 s28, s78
    s_mov_b32 s29, s79
    s_mov_b32 s8, s64
    s_mov_b32 s9, s65
    s_mov_b32 s10, 1835008
    s_mov_b32 s11, 0x00020000
    s_mov_b32 s12, s72
    s_mov_b32 s13, s73
    s_mov_b32 s14, 1605632
    s_mov_b32 s15, 0x00020000
    s_add_u32 m0, s61, 0
    s_nop 0
    buffer_load_dwordx4 v4, s[8:11], s16 offen lds
    s_add_u32 m0, s45, 16384
    s_nop 0
    buffer_load_dwordx4 v126, s[12:15], s23 offen lds
    s_add_u32 m0, s61, 1024
    s_nop 0
    buffer_load_dwordx4 v5, s[8:11], s16 offen lds
    s_lshl_b32 s5, s4, 7
    s_add_u32 s17, s5, s6
    s_mul_i32 s5, s4, 229376
    s_add_u32 s24, s5, s44
    s_add_u32 s4, s4, 1
    s_cmp_eq_u32 s4, 7
    s_cselect_b32 s4, 0, s4
    s_lshl_b32 s5, s4, 7
    s_add_u32 s18, s5, s6
    s_mul_i32 s5, s4, 229376
    s_add_u32 s25, s5, s44
    s_add_u32 s4, s4, 1
    s_cmp_eq_u32 s4, 7
    s_cselect_b32 s4, 0, s4
    s_lshl_b32 s5, s4, 7
    s_add_u32 s19, s5, s6
    s_mul_i32 s5, s4, 229376
    s_add_u32 s26, s5, s44
    s_add_u32 s4, s4, 1
    s_cmp_eq_u32 s4, 7
    s_cselect_b32 s4, 0, s4
    s_lshl_b32 s5, s4, 7
    s_add_u32 s20, s5, s6
    s_mul_i32 s5, s4, 229376
    s_add_u32 s27, s5, s44
    s_add_u32 s4, s4, 1
    s_cmp_eq_u32 s4, 7
    s_cselect_b32 s4, 0, s4
    s_lshl_b32 s5, s4, 7
    s_add_u32 s21, s5, s6
    s_mul_i32 s5, s4, 229376
    s_add_u32 s46, s5, s44
    s_add_u32 s4, s4, 1
    s_cmp_eq_u32 s4, 7
    s_cselect_b32 s4, 0, s4
    s_lshl_b32 s5, s4, 7
    s_add_u32 s22, s5, s6
    s_mul_i32 s5, s4, 229376
    s_add_u32 s47, s5, s44
    s_barrier
    s_add_u32 m0, s61, 24576
    s_nop 0
    buffer_load_dwordx4 v4, s[8:11], s17 offen lds
    s_add_u32 m0, s45, 40960
    s_nop 0
    buffer_load_dwordx4 v126, s[12:15], s24 offen lds
    s_add_u32 m0, s61, 25600
    s_nop 0
    buffer_load_dwordx4 v5, s[8:11], s17 offen lds
    v_lshrrev_b32 v28, 1, v2
    v_and_b32 v28, 7, v28
    v_xor_b32 v28, v28, v3
    v_lshlrev_b32 v28, 4, v28
    v_lshl_add_u32 v28, v2, 7, v28
    s_lshl_b32 s5, s31, 12
    v_add_u32 v8, s5, v28
    v_xor_b32 v9, 32, v8
    v_xor_b32 v10, 64, v8
    v_xor_b32 v11, 0x60, v8
    v_add_u32 v12, 0xc000, v8
    v_add_u32 v13, 0xc000, v9
    v_add_u32 v14, 0xc000, v10
    v_add_u32 v15, 0xc000, v11
    v_bfe_u32 v29, v1, 2, 2
    v_lshl_add_u32 v30, v3, 3, v29
    v_lshlrev_b32 v30, 7, v30
    v_and_b32 v25, 3, v1
    v_lshlrev_b32 v25, 3, v25
    v_bfe_u32 v24, v1, 4, 1
    v_lshl_add_u32 v26, v24, 5, v25
    v_lshrrev_b32 v27, 1, v29
    v_lshl_add_u32 v26, v27, 6, v26
    v_add_u32 v16, v30, v26
    v_xor_b32 v17, 64, v16
    s_mov_b32 s60, 0xffff0000
    s_cmp_eq_u32 s32, 1
    s_cbranch_scc1 recurrent_scan__ssm_conv_h3__mixer_gmlp__prompt_kernel_z1
    s_mov_b32 s56, s76
    s_mov_b32 s57, s77
    s_mov_b32 s58, 256
    s_mov_b32 s59, 0x00020000
    v_add_u32 v18, 0x10000, v16
    v_add_u32 v19, 0x10000, v17
    v_add_u32 v16, 0x4000, v16
    v_add_u32 v17, 0x4000, v17
    v_mov_b32 v221, 0
    s_mov_b32 s36, s28
    s_mov_b32 s37, s29
    s_mov_b32 s38, 67108864
    s_mov_b32 s39, 0x00020000
    s_lshl_b32 s4, s33, 2
    s_add_u32 s4, s4, s31
    s_mul_i32 s4, s4, 7168
    s_lshl_b32 s5, s34, 9
    s_add_u32 s4, s4, s5
    s_add_u32 s4, s4, 15499264
    v_lshlrev_b32 v219, 7, v1
    v_add_u32 v219, s4, v219
    s_lshl_b32 s4, s34, 11
    s_lshl_b32 s5, s33, 7
    s_add_u32 s4, s4, s5
    s_add_u32 s4, s4, 16560128
    v_writelane_b32 v219, s4, 4
    s_add_u32 s4, s4, 65536
    v_writelane_b32 v219, s4, 5
    s_and_b32 s4, s35, 3
    s_lshl_b32 s4, s4, 3
    s_and_b32 s5, s3, 7
    s_add_u32 s4, s4, s5
    s_lshl_b32 s4, s4, 3
    s_lshr_b32 s5, s35, 2
    s_lshl_b32 s5, s5, 2
    s_add_u32 s4, s4, s5
    s_lshr_b32 s5, s3, 3
    s_add_u32 s4, s4, s5
    s_lshl_b32 s4, s4, 2
    s_add_u32 s4, s4, s31
    s_lshl_b32 s4, s4, 7
    s_add_u32 s4, s4, 16429056
    v_writelane_b32 v219, s4, 6
    s_mov_b32 s52, s74
    s_mov_b32 s53, s75
    s_mov_b32 s54, 8388608
    s_mov_b32 s55, 0x00020000
    s_and_b32 s4, s35, 3
    s_lshl_b32 s4, s4, 21
    s_lshr_b32 s5, s35, 2
    s_lshl_b32 s5, s5, 20
    s_add_u32 s4, s4, s5
    s_lshl_b32 s5, s3, 15
    s_add_u32 s4, s4, s5
    s_lshl_b32 s5, s31, 13
    s_add_u32 s40, s4, s5
    v_lshlrev_b32 v220, 7, v1
    s_waitcnt vmcnt(3)
    s_barrier
    ds_read_b128 v[64:67], v8 offset:0
    ds_read_b64_tr_b16 v[68:69], v16 offset:0
    ds_read_b64_tr_b16 v[70:71], v16 offset:512
    ds_read_b64_tr_b16 v[72:73], v17 offset:0
    ds_read_b64_tr_b16 v[74:75], v17 offset:512
    s_add_u32 m0, s61, 49152
    s_nop 0
    buffer_load_dwordx4 v4, s[8:11], s18 offen lds
    s_add_u32 m0, s45, 65536
    s_nop 0
    buffer_load_dwordx4 v126, s[12:15], s25 offen lds
    ds_read_b128 v[76:79], v9 offset:0
    ds_read_b64_tr_b16 v[80:81], v16 offset:2048
    ds_read_b64_tr_b16 v[82:83], v16 offset:2560
    ds_read_b64_tr_b16 v[84:85], v17 offset:2048
    ds_read_b64_tr_b16 v[86:87], v17 offset:2560
    s_add_u32 m0, s61, 50176
    s_nop 0
    buffer_load_dwordx4 v5, s[8:11], s18 offen lds
    s_add_u32 m0, s61, 73728
    s_nop 0
    buffer_load_dwordx4 v4, s[8:11], s19 offen lds
    ds_read_b128 v[88:91], v10 offset:0
    ds_read_b64_tr_b16 v[92:93], v16 offset:4096
    ds_read_b64_tr_b16 v[94:95], v16 offset:4608
    ds_read_b64_tr_b16 v[96:97], v17 offset:4096
    ds_read_b64_tr_b16 v[98:99], v17 offset:4608
    s_add_u32 m0, s45, 90112
    s_nop 0
    buffer_load_dwordx4 v126, s[12:15], s26 offen lds
    s_add_u32 m0, s61, 74752
    s_nop 0
    buffer_load_dwordx4 v5, s[8:11], s19 offen lds
    ds_read_b128 v[100:103], v11 offset:0
    ds_read_b64_tr_b16 v[104:105], v16 offset:6144
    ds_read_b64_tr_b16 v[106:107], v16 offset:6656
    ds_read_b64_tr_b16 v[108:109], v17 offset:6144
    ds_read_b64_tr_b16 v[110:111], v17 offset:6656
    s_waitcnt lgkmcnt(0)
    s_waitcnt vmcnt(6)
    s_barrier
    v_mfma_f32_32x32x16_bf16 v[32:47], v[68:71], v[64:67], 0
    ds_read_b128 v[128:131], v8 offset:24576
    ds_read_b64_tr_b16 v[132:133], v16 offset:24576
    ds_read_b64_tr_b16 v[134:135], v16 offset:25088
    ds_read_b64_tr_b16 v[136:137], v17 offset:24576
    ds_read_b64_tr_b16 v[138:139], v17 offset:25088
    v_mfma_f32_32x32x16_bf16 v[48:63], v[72:75], v[64:67], 0
    s_add_u32 m0, s61, 0
    s_nop 0
    buffer_load_dwordx4 v4, s[8:11], s20 offen lds
    v_mfma_f32_32x32x16_bf16 v[32:47], v[80:83], v[76:79], v[32:47]
    ds_read_b128 v[140:143], v9 offset:24576
    ds_read_b64_tr_b16 v[144:145], v16 offset:26624
    ds_read_b64_tr_b16 v[146:147], v16 offset:27136
    ds_read_b64_tr_b16 v[148:149], v17 offset:26624
    ds_read_b64_tr_b16 v[150:151], v17 offset:27136
    v_mfma_f32_32x32x16_bf16 v[48:63], v[84:87], v[76:79], v[48:63]
    s_add_u32 m0, s45, 16384
    s_nop 0
    buffer_load_dwordx4 v126, s[12:15], s27 offen lds
    v_mfma_f32_32x32x16_bf16 v[32:47], v[92:95], v[88:91], v[32:47]
    ds_read_b128 v[152:155], v10 offset:24576
    ds_read_b64_tr_b16 v[156:157], v16 offset:28672
    ds_read_b64_tr_b16 v[158:159], v16 offset:29184
    ds_read_b64_tr_b16 v[160:161], v17 offset:28672
    ds_read_b64_tr_b16 v[162:163], v17 offset:29184
    v_mfma_f32_32x32x16_bf16 v[48:63], v[96:99], v[88:91], v[48:63]
    s_add_u32 m0, s61, 1024
    s_nop 0
    buffer_load_dwordx4 v5, s[8:11], s20 offen lds
    v_mfma_f32_32x32x16_bf16 v[32:47], v[104:107], v[100:103], v[32:47]
    ds_read_b128 v[164:167], v11 offset:24576
    ds_read_b64_tr_b16 v[168:169], v16 offset:30720
    ds_read_b64_tr_b16 v[170:171], v16 offset:31232
    ds_read_b64_tr_b16 v[172:173], v17 offset:30720
    ds_read_b64_tr_b16 v[174:175], v17 offset:31232
    v_mfma_f32_32x32x16_bf16 v[48:63], v[108:111], v[100:103], v[48:63]
    s_waitcnt lgkmcnt(0)
    s_waitcnt vmcnt(6)
    s_barrier
    v_mfma_f32_32x32x16_bf16 v[32:47], v[132:135], v[128:131], v[32:47]
    ds_read_b128 v[64:67], v12 offset:0
    ds_read_b64_tr_b16 v[68:69], v18 offset:0
    ds_read_b64_tr_b16 v[70:71], v18 offset:512
    ds_read_b64_tr_b16 v[72:73], v19 offset:0
    ds_read_b64_tr_b16 v[74:75], v19 offset:512
    v_mfma_f32_32x32x16_bf16 v[48:63], v[136:139], v[128:131], v[48:63]
    s_add_u32 m0, s61, 24576
    s_nop 0
    buffer_load_dwordx4 v4, s[8:11], s21 offen lds
    v_mfma_f32_32x32x16_bf16 v[32:47], v[144:147], v[140:143], v[32:47]
    ds_read_b128 v[76:79], v13 offset:0
    ds_read_b64_tr_b16 v[80:81], v18 offset:2048
    ds_read_b64_tr_b16 v[82:83], v18 offset:2560
    ds_read_b64_tr_b16 v[84:85], v19 offset:2048
    ds_read_b64_tr_b16 v[86:87], v19 offset:2560
    v_mfma_f32_32x32x16_bf16 v[48:63], v[148:151], v[140:143], v[48:63]
    s_add_u32 m0, s45, 40960
    s_nop 0
    buffer_load_dwordx4 v126, s[12:15], s46 offen lds
    v_mfma_f32_32x32x16_bf16 v[32:47], v[156:159], v[152:155], v[32:47]
    ds_read_b128 v[88:91], v14 offset:0
    ds_read_b64_tr_b16 v[92:93], v18 offset:4096
    ds_read_b64_tr_b16 v[94:95], v18 offset:4608
    ds_read_b64_tr_b16 v[96:97], v19 offset:4096
    ds_read_b64_tr_b16 v[98:99], v19 offset:4608
    v_mfma_f32_32x32x16_bf16 v[48:63], v[160:163], v[152:155], v[48:63]
    s_add_u32 m0, s61, 25600
    s_nop 0
    buffer_load_dwordx4 v5, s[8:11], s21 offen lds
    v_mfma_f32_32x32x16_bf16 v[32:47], v[168:171], v[164:167], v[32:47]
    ds_read_b128 v[100:103], v15 offset:0
    ds_read_b64_tr_b16 v[104:105], v18 offset:6144
    ds_read_b64_tr_b16 v[106:107], v18 offset:6656
    ds_read_b64_tr_b16 v[108:109], v19 offset:6144
    ds_read_b64_tr_b16 v[110:111], v19 offset:6656
    v_mfma_f32_32x32x16_bf16 v[48:63], v[172:175], v[164:167], v[48:63]
    s_waitcnt lgkmcnt(0)
    s_waitcnt vmcnt(6)
    s_barrier
    v_mfma_f32_32x32x16_bf16 v[32:47], v[68:71], v[64:67], v[32:47]
    ds_read_b128 v[128:131], v12 offset:24576
    ds_read_b64_tr_b16 v[132:133], v18 offset:24576
    ds_read_b64_tr_b16 v[134:135], v18 offset:25088
    ds_read_b64_tr_b16 v[136:137], v19 offset:24576
    ds_read_b64_tr_b16 v[138:139], v19 offset:25088
    v_mfma_f32_32x32x16_bf16 v[48:63], v[72:75], v[64:67], v[48:63]
    s_add_u32 m0, s61, 49152
    s_nop 0
    buffer_load_dwordx4 v4, s[8:11], s22 offen lds
    v_mfma_f32_32x32x16_bf16 v[32:47], v[80:83], v[76:79], v[32:47]
    ds_read_b128 v[140:143], v13 offset:24576
    ds_read_b64_tr_b16 v[144:145], v18 offset:26624
    ds_read_b64_tr_b16 v[146:147], v18 offset:27136
    ds_read_b64_tr_b16 v[148:149], v19 offset:26624
    ds_read_b64_tr_b16 v[150:151], v19 offset:27136
    v_mfma_f32_32x32x16_bf16 v[48:63], v[84:87], v[76:79], v[48:63]
    s_add_u32 m0, s45, 65536
    s_nop 0
    buffer_load_dwordx4 v126, s[12:15], s47 offen lds
    v_mfma_f32_32x32x16_bf16 v[32:47], v[92:95], v[88:91], v[32:47]
    ds_read_b128 v[152:155], v14 offset:24576
    ds_read_b64_tr_b16 v[156:157], v18 offset:28672
    ds_read_b64_tr_b16 v[158:159], v18 offset:29184
    ds_read_b64_tr_b16 v[160:161], v19 offset:28672
    ds_read_b64_tr_b16 v[162:163], v19 offset:29184
    v_mfma_f32_32x32x16_bf16 v[48:63], v[96:99], v[88:91], v[48:63]
    s_add_u32 m0, s61, 50176
    s_nop 0
    buffer_load_dwordx4 v5, s[8:11], s22 offen lds
    v_mfma_f32_32x32x16_bf16 v[32:47], v[104:107], v[100:103], v[32:47]
    ds_read_b128 v[164:167], v15 offset:24576
    ds_read_b64_tr_b16 v[168:169], v18 offset:30720
    ds_read_b64_tr_b16 v[170:171], v18 offset:31232
    ds_read_b64_tr_b16 v[172:173], v19 offset:30720
    ds_read_b64_tr_b16 v[174:175], v19 offset:31232
    v_mfma_f32_32x32x16_bf16 v[48:63], v[108:111], v[100:103], v[48:63]
    s_mov_b64 exec, 0x7f
    buffer_load_dword v218, v219, s[36:39], 0 offen sc1
    s_mov_b64 exec, -1
    s_waitcnt lgkmcnt(0)
    s_waitcnt vmcnt(7)
    s_barrier
    v_mfma_f32_32x32x16_bf16 v[32:47], v[132:135], v[128:131], v[32:47]
    ds_read_b128 v[64:67], v8 offset:0
    ds_read_b64_tr_b16 v[68:69], v16 offset:0
    ds_read_b64_tr_b16 v[70:71], v16 offset:512
    ds_read_b64_tr_b16 v[72:73], v17 offset:0
    ds_read_b64_tr_b16 v[74:75], v17 offset:512
    v_mfma_f32_32x32x16_bf16 v[48:63], v[136:139], v[128:131], v[48:63]
    buffer_load_dword v223, v221, s[56:59], 0 offen sc1
    v_mfma_f32_32x32x16_bf16 v[32:47], v[144:147], v[140:143], v[32:47]
    ds_read_b128 v[76:79], v9 offset:0
    ds_read_b64_tr_b16 v[80:81], v16 offset:2048
    ds_read_b64_tr_b16 v[82:83], v16 offset:2560
    ds_read_b64_tr_b16 v[84:85], v17 offset:2048
    ds_read_b64_tr_b16 v[86:87], v17 offset:2560
    v_mfma_f32_32x32x16_bf16 v[48:63], v[148:151], v[140:143], v[48:63]
    s_mov_b32 exec_lo, 0xffffffff
    s_mov_b32 exec_hi, 0x0
    buffer_load_dword v222, v220, s[52:55], s40 offen
    s_mov_b64 exec, -1
    v_mfma_f32_32x32x16_bf16 v[32:47], v[156:159], v[152:155], v[32:47]
    ds_read_b128 v[88:91], v10 offset:0
    ds_read_b64_tr_b16 v[92:93], v16 offset:4096
    ds_read_b64_tr_b16 v[94:95], v16 offset:4608
    ds_read_b64_tr_b16 v[96:97], v17 offset:4096
    ds_read_b64_tr_b16 v[98:99], v17 offset:4608
    v_mfma_f32_32x32x16_bf16 v[48:63], v[160:163], v[152:155], v[48:63]
    v_mfma_f32_32x32x16_bf16 v[32:47], v[168:171], v[164:167], v[32:47]
    ds_read_b128 v[100:103], v11 offset:0
    ds_read_b64_tr_b16 v[104:105], v16 offset:6144
    ds_read_b64_tr_b16 v[106:107], v16 offset:6656
    ds_read_b64_tr_b16 v[108:109], v17 offset:6144
    ds_read_b64_tr_b16 v[110:111], v17 offset:6656
    v_mfma_f32_32x32x16_bf16 v[48:63], v[172:175], v[164:167], v[48:63]
    s_waitcnt lgkmcnt(0)
    s_waitcnt vmcnt(6)
    s_barrier
    v_mfma_f32_32x32x16_bf16 v[32:47], v[68:71], v[64:67], v[32:47]
    ds_read_b128 v[128:131], v8 offset:24576
    ds_read_b64_tr_b16 v[132:133], v16 offset:24576
    ds_read_b64_tr_b16 v[134:135], v16 offset:25088
    ds_read_b64_tr_b16 v[136:137], v17 offset:24576
    ds_read_b64_tr_b16 v[138:139], v17 offset:25088
    v_mfma_f32_32x32x16_bf16 v[48:63], v[72:75], v[64:67], v[48:63]
    v_mfma_f32_32x32x16_bf16 v[32:47], v[80:83], v[76:79], v[32:47]
    ds_read_b128 v[140:143], v9 offset:24576
    ds_read_b64_tr_b16 v[144:145], v16 offset:26624
    ds_read_b64_tr_b16 v[146:147], v16 offset:27136
    ds_read_b64_tr_b16 v[148:149], v17 offset:26624
    ds_read_b64_tr_b16 v[150:151], v17 offset:27136
    v_mfma_f32_32x32x16_bf16 v[48:63], v[84:87], v[76:79], v[48:63]
    v_mfma_f32_32x32x16_bf16 v[32:47], v[92:95], v[88:91], v[32:47]
    ds_read_b128 v[152:155], v10 offset:24576
    ds_read_b64_tr_b16 v[156:157], v16 offset:28672
    ds_read_b64_tr_b16 v[158:159], v16 offset:29184
    ds_read_b64_tr_b16 v[160:161], v17 offset:28672
    ds_read_b64_tr_b16 v[162:163], v17 offset:29184
    v_mfma_f32_32x32x16_bf16 v[48:63], v[96:99], v[88:91], v[48:63]
    v_mfma_f32_32x32x16_bf16 v[32:47], v[104:107], v[100:103], v[32:47]
    ds_read_b128 v[164:167], v11 offset:24576
    ds_read_b64_tr_b16 v[168:169], v16 offset:30720
    ds_read_b64_tr_b16 v[170:171], v16 offset:31232
    ds_read_b64_tr_b16 v[172:173], v17 offset:30720
    ds_read_b64_tr_b16 v[174:175], v17 offset:31232
    v_mfma_f32_32x32x16_bf16 v[48:63], v[108:111], v[100:103], v[48:63]
    s_waitcnt lgkmcnt(0)
    s_waitcnt vmcnt(3)
    s_barrier
    v_mfma_f32_32x32x16_bf16 v[32:47], v[132:135], v[128:131], v[32:47]
    ds_read_b128 v[64:67], v12 offset:0
    ds_read_b64_tr_b16 v[68:69], v18 offset:0
    ds_read_b64_tr_b16 v[70:71], v18 offset:512
    ds_read_b64_tr_b16 v[72:73], v19 offset:0
    ds_read_b64_tr_b16 v[74:75], v19 offset:512
    v_mfma_f32_32x32x16_bf16 v[48:63], v[136:139], v[128:131], v[48:63]
    s_mov_b32 exec_lo, 0x0
    s_mov_b32 exec_hi, 0xffffffff
    buffer_load_dword v222, v220, s[52:55], s40 offen
    s_mov_b64 exec, -1
    v_mfma_f32_32x32x16_bf16 v[32:47], v[144:147], v[140:143], v[32:47]
    ds_read_b128 v[76:79], v13 offset:0
    ds_read_b64_tr_b16 v[80:81], v18 offset:2048
    ds_read_b64_tr_b16 v[82:83], v18 offset:2560
    ds_read_b64_tr_b16 v[84:85], v19 offset:2048
    ds_read_b64_tr_b16 v[86:87], v19 offset:2560
    v_mfma_f32_32x32x16_bf16 v[48:63], v[148:151], v[140:143], v[48:63]
    v_mfma_f32_32x32x16_bf16 v[32:47], v[156:159], v[152:155], v[32:47]
    ds_read_b128 v[88:91], v14 offset:0
    ds_read_b64_tr_b16 v[92:93], v18 offset:4096
    ds_read_b64_tr_b16 v[94:95], v18 offset:4608
    ds_read_b64_tr_b16 v[96:97], v19 offset:4096
    ds_read_b64_tr_b16 v[98:99], v19 offset:4608
    v_mfma_f32_32x32x16_bf16 v[48:63], v[160:163], v[152:155], v[48:63]
    v_mfma_f32_32x32x16_bf16 v[32:47], v[168:171], v[164:167], v[32:47]
    ds_read_b128 v[100:103], v15 offset:0
    ds_read_b64_tr_b16 v[104:105], v18 offset:6144
    ds_read_b64_tr_b16 v[106:107], v18 offset:6656
    ds_read_b64_tr_b16 v[108:109], v19 offset:6144
    ds_read_b64_tr_b16 v[110:111], v19 offset:6656
    v_mfma_f32_32x32x16_bf16 v[48:63], v[172:175], v[164:167], v[48:63]
    s_waitcnt lgkmcnt(0)
    v_mfma_f32_32x32x16_bf16 v[32:47], v[68:71], v[64:67], v[32:47]
    v_mfma_f32_32x32x16_bf16 v[48:63], v[72:75], v[64:67], v[48:63]
    v_mfma_f32_32x32x16_bf16 v[32:47], v[80:83], v[76:79], v[32:47]
    v_mfma_f32_32x32x16_bf16 v[48:63], v[84:87], v[76:79], v[48:63]
    v_mfma_f32_32x32x16_bf16 v[32:47], v[92:95], v[88:91], v[32:47]
    v_mfma_f32_32x32x16_bf16 v[48:63], v[96:99], v[88:91], v[48:63]
    v_mfma_f32_32x32x16_bf16 v[32:47], v[104:107], v[100:103], v[32:47]
    v_mfma_f32_32x32x16_bf16 v[48:63], v[108:111], v[100:103], v[48:63]
    s_lshl_b32 s4, s31, 8
    s_add_u32 s4, s4, 155648
    v_lshlrev_b32 v102, 3, v2
    v_add_u32 v102, s4, v102
    v_mov_b32 v98, 0
    v_mov_b32 v99, 0
    v_mov_b32 v100, 0
    v_mov_b32 v101, 0
    s_barrier
    ds_read_b64 v[24:25], v102
    v_lshlrev_b32 v96, 4, v1
    v_add_u32 v96, 158720, v96
    ds_read_b128 v[64:67], v96
    s_lshl_b32 s4, s30, 8
    s_add_u32 s4, s4, 156672
    v_lshlrev_b32 v96, 2, v1
    v_add_u32 v96, s4, v96
    v_lshlrev_b32 v97, 4, v3
    v_add_u32 v97, s4, v97
    s_waitcnt lgkmcnt(0)
    v_add_f32 v64, v64, v65
    v_add_f32 v66, v66, v67
    v_add_f32 v64, v64, v66
    ds_write_b32 v96, v64
    s_waitcnt lgkmcnt(0)
    ds_read_b128 v[64:67], v97 offset:0
    ds_read_b128 v[68:71], v97 offset:32
    ds_read_b128 v[72:75], v97 offset:64
    ds_read_b128 v[76:79], v97 offset:96
    ds_read_b128 v[80:83], v97 offset:128
    ds_read_b128 v[84:87], v97 offset:160
    ds_read_b128 v[88:91], v97 offset:192
    ds_read_b128 v[92:95], v97 offset:224
    v_mul_f32 v108, v25, v25
    v_mul_f32 v106, 0xc0135761, v25
    v_mul_f32 v108, v108, v106
    v_mul_f32 v108, 0x3d372713, v108
    v_sub_f32 v104, 0, v24
    v_sub_f32 v105, 0, v24
    v_mov_b32 v107, v106
    v_mov_b32 v109, v108
    s_mov_b32 s62, 1.0
    s_mov_b32 s63, 1.0
    s_waitcnt lgkmcnt(6)
    v_pk_fma_f32 v[32:33], v[104:105], v[64:65], v[32:33]
    v_pk_fma_f32 v[34:35], v[104:105], v[66:67], v[34:35]
    v_pk_fma_f32 v[36:37], v[104:105], v[68:69], v[36:37]
    v_pk_fma_f32 v[38:39], v[104:105], v[70:71], v[38:39]
    v_pk_mul_f32 v[64:65], v[32:33], v[32:33]
    v_pk_mul_f32 v[66:67], v[34:35], v[34:35]
    v_pk_mul_f32 v[68:69], v[36:37], v[36:37]
    v_pk_mul_f32 v[70:71], v[38:39], v[38:39]
    v_pk_fma_f32 v[64:65], v[64:65], v[108:109], v[106:107]
    v_pk_fma_f32 v[66:67], v[66:67], v[108:109], v[106:107]
    v_pk_fma_f32 v[68:69], v[68:69], v[108:109], v[106:107]
    v_pk_fma_f32 v[70:71], v[70:71], v[108:109], v[106:107]
    v_pk_mul_f32 v[64:65], v[64:65], v[32:33]
    v_pk_mul_f32 v[66:67], v[66:67], v[34:35]
    v_pk_mul_f32 v[68:69], v[68:69], v[36:37]
    v_pk_mul_f32 v[70:71], v[70:71], v[38:39]
    v_exp_f32 v64, v64
    v_exp_f32 v65, v65
    v_exp_f32 v66, v66
    v_exp_f32 v67, v67
    v_exp_f32 v68, v68
    v_exp_f32 v69, v69
    v_exp_f32 v70, v70
    v_exp_f32 v71, v71
    v_pk_add_f32 v[64:65], v[64:65], s[62:63]
    v_pk_add_f32 v[66:67], v[66:67], s[62:63]
    v_pk_add_f32 v[68:69], v[68:69], s[62:63]
    v_pk_add_f32 v[70:71], v[70:71], s[62:63]
    v_rcp_f32 v64, v64
    v_rcp_f32 v65, v65
    v_rcp_f32 v66, v66
    v_rcp_f32 v67, v67
    v_rcp_f32 v68, v68
    v_rcp_f32 v69, v69
    v_rcp_f32 v70, v70
    v_rcp_f32 v71, v71
    v_pk_mul_f32 v[32:33], v[32:33], v[64:65]
    v_pk_mul_f32 v[34:35], v[34:35], v[66:67]
    v_pk_mul_f32 v[36:37], v[36:37], v[68:69]
    v_pk_mul_f32 v[38:39], v[38:39], v[70:71]
    v_pk_add_f32 v[98:99], v[98:99], v[32:33]
    v_pk_fma_f32 v[100:101], v[32:33], v[32:33], v[100:101]
    v_pk_add_f32 v[98:99], v[98:99], v[34:35]
    v_pk_fma_f32 v[100:101], v[34:35], v[34:35], v[100:101]
    v_pk_add_f32 v[98:99], v[98:99], v[36:37]
    v_pk_fma_f32 v[100:101], v[36:37], v[36:37], v[100:101]
    v_pk_add_f32 v[98:99], v[98:99], v[38:39]
    v_pk_fma_f32 v[100:101], v[38:39], v[38:39], v[100:101]
    s_waitcnt lgkmcnt(4)
    v_pk_fma_f32 v[40:41], v[104:105], v[72:73], v[40:41]
    v_pk_fma_f32 v[42:43], v[104:105], v[74:75], v[42:43]
    v_pk_fma_f32 v[44:45], v[104:105], v[76:77], v[44:45]
    v_pk_fma_f32 v[46:47], v[104:105], v[78:79], v[46:47]
    v_pk_mul_f32 v[72:73], v[40:41], v[40:41]
    v_pk_mul_f32 v[74:75], v[42:43], v[42:43]
    v_pk_mul_f32 v[76:77], v[44:45], v[44:45]
    v_pk_mul_f32 v[78:79], v[46:47], v[46:47]
    v_pk_fma_f32 v[72:73], v[72:73], v[108:109], v[106:107]
    v_pk_fma_f32 v[74:75], v[74:75], v[108:109], v[106:107]
    v_pk_fma_f32 v[76:77], v[76:77], v[108:109], v[106:107]
    v_pk_fma_f32 v[78:79], v[78:79], v[108:109], v[106:107]
    v_pk_mul_f32 v[72:73], v[72:73], v[40:41]
    v_pk_mul_f32 v[74:75], v[74:75], v[42:43]
    v_pk_mul_f32 v[76:77], v[76:77], v[44:45]
    v_pk_mul_f32 v[78:79], v[78:79], v[46:47]
    v_exp_f32 v72, v72
    v_exp_f32 v73, v73
    v_exp_f32 v74, v74
    v_exp_f32 v75, v75
    v_exp_f32 v76, v76
    v_exp_f32 v77, v77
    v_exp_f32 v78, v78
    v_exp_f32 v79, v79
    v_pk_add_f32 v[72:73], v[72:73], s[62:63]
    v_pk_add_f32 v[74:75], v[74:75], s[62:63]
    v_pk_add_f32 v[76:77], v[76:77], s[62:63]
    v_pk_add_f32 v[78:79], v[78:79], s[62:63]
    v_rcp_f32 v72, v72
    v_rcp_f32 v73, v73
    v_rcp_f32 v74, v74
    v_rcp_f32 v75, v75
    v_rcp_f32 v76, v76
    v_rcp_f32 v77, v77
    v_rcp_f32 v78, v78
    v_rcp_f32 v79, v79
    v_pk_mul_f32 v[40:41], v[40:41], v[72:73]
    v_pk_mul_f32 v[42:43], v[42:43], v[74:75]
    v_pk_mul_f32 v[44:45], v[44:45], v[76:77]
    v_pk_mul_f32 v[46:47], v[46:47], v[78:79]
    v_pk_add_f32 v[98:99], v[98:99], v[40:41]
    v_pk_fma_f32 v[100:101], v[40:41], v[40:41], v[100:101]
    v_pk_add_f32 v[98:99], v[98:99], v[42:43]
    v_pk_fma_f32 v[100:101], v[42:43], v[42:43], v[100:101]
    v_pk_add_f32 v[98:99], v[98:99], v[44:45]
    v_pk_fma_f32 v[100:101], v[44:45], v[44:45], v[100:101]
    v_pk_add_f32 v[98:99], v[98:99], v[46:47]
    v_pk_fma_f32 v[100:101], v[46:47], v[46:47], v[100:101]
    s_waitcnt lgkmcnt(2)
    v_pk_fma_f32 v[48:49], v[104:105], v[80:81], v[48:49]
    v_pk_fma_f32 v[50:51], v[104:105], v[82:83], v[50:51]
    v_pk_fma_f32 v[52:53], v[104:105], v[84:85], v[52:53]
    v_pk_fma_f32 v[54:55], v[104:105], v[86:87], v[54:55]
    v_pk_mul_f32 v[80:81], v[48:49], v[48:49]
    v_pk_mul_f32 v[82:83], v[50:51], v[50:51]
    v_pk_mul_f32 v[84:85], v[52:53], v[52:53]
    v_pk_mul_f32 v[86:87], v[54:55], v[54:55]
    v_pk_fma_f32 v[80:81], v[80:81], v[108:109], v[106:107]
    v_pk_fma_f32 v[82:83], v[82:83], v[108:109], v[106:107]
    v_pk_fma_f32 v[84:85], v[84:85], v[108:109], v[106:107]
    v_pk_fma_f32 v[86:87], v[86:87], v[108:109], v[106:107]
    v_pk_mul_f32 v[80:81], v[80:81], v[48:49]
    v_pk_mul_f32 v[82:83], v[82:83], v[50:51]
    v_pk_mul_f32 v[84:85], v[84:85], v[52:53]
    v_pk_mul_f32 v[86:87], v[86:87], v[54:55]
    v_exp_f32 v80, v80
    v_exp_f32 v81, v81
    v_exp_f32 v82, v82
    v_exp_f32 v83, v83
    v_exp_f32 v84, v84
    v_exp_f32 v85, v85
    v_exp_f32 v86, v86
    v_exp_f32 v87, v87
    v_pk_add_f32 v[80:81], v[80:81], s[62:63]
    v_pk_add_f32 v[82:83], v[82:83], s[62:63]
    v_pk_add_f32 v[84:85], v[84:85], s[62:63]
    v_pk_add_f32 v[86:87], v[86:87], s[62:63]
    v_rcp_f32 v80, v80
    v_rcp_f32 v81, v81
    v_rcp_f32 v82, v82
    v_rcp_f32 v83, v83
    v_rcp_f32 v84, v84
    v_rcp_f32 v85, v85
    v_rcp_f32 v86, v86
    v_rcp_f32 v87, v87
    v_pk_mul_f32 v[48:49], v[48:49], v[80:81]
    v_pk_mul_f32 v[50:51], v[50:51], v[82:83]
    v_pk_mul_f32 v[52:53], v[52:53], v[84:85]
    v_pk_mul_f32 v[54:55], v[54:55], v[86:87]
    v_pk_add_f32 v[98:99], v[98:99], v[48:49]
    v_pk_fma_f32 v[100:101], v[48:49], v[48:49], v[100:101]
    v_pk_add_f32 v[98:99], v[98:99], v[50:51]
    v_pk_fma_f32 v[100:101], v[50:51], v[50:51], v[100:101]
    v_pk_add_f32 v[98:99], v[98:99], v[52:53]
    v_pk_fma_f32 v[100:101], v[52:53], v[52:53], v[100:101]
    v_pk_add_f32 v[98:99], v[98:99], v[54:55]
    v_pk_fma_f32 v[100:101], v[54:55], v[54:55], v[100:101]
    s_waitcnt lgkmcnt(0)
    v_pk_fma_f32 v[56:57], v[104:105], v[88:89], v[56:57]
    v_pk_fma_f32 v[58:59], v[104:105], v[90:91], v[58:59]
    v_pk_fma_f32 v[60:61], v[104:105], v[92:93], v[60:61]
    v_pk_fma_f32 v[62:63], v[104:105], v[94:95], v[62:63]
    v_pk_mul_f32 v[88:89], v[56:57], v[56:57]
    v_pk_mul_f32 v[90:91], v[58:59], v[58:59]
    v_pk_mul_f32 v[92:93], v[60:61], v[60:61]
    v_pk_mul_f32 v[94:95], v[62:63], v[62:63]
    v_pk_fma_f32 v[88:89], v[88:89], v[108:109], v[106:107]
    v_pk_fma_f32 v[90:91], v[90:91], v[108:109], v[106:107]
    v_pk_fma_f32 v[92:93], v[92:93], v[108:109], v[106:107]
    v_pk_fma_f32 v[94:95], v[94:95], v[108:109], v[106:107]
    v_pk_mul_f32 v[88:89], v[88:89], v[56:57]
    v_pk_mul_f32 v[90:91], v[90:91], v[58:59]
    v_pk_mul_f32 v[92:93], v[92:93], v[60:61]
    v_pk_mul_f32 v[94:95], v[94:95], v[62:63]
    v_exp_f32 v88, v88
    v_exp_f32 v89, v89
    v_exp_f32 v90, v90
    v_exp_f32 v91, v91
    v_exp_f32 v92, v92
    v_exp_f32 v93, v93
    v_exp_f32 v94, v94
    v_exp_f32 v95, v95
    v_pk_add_f32 v[88:89], v[88:89], s[62:63]
    v_pk_add_f32 v[90:91], v[90:91], s[62:63]
    v_pk_add_f32 v[92:93], v[92:93], s[62:63]
    v_pk_add_f32 v[94:95], v[94:95], s[62:63]
    v_rcp_f32 v88, v88
    v_rcp_f32 v89, v89
    v_rcp_f32 v90, v90
    v_rcp_f32 v91, v91
    v_rcp_f32 v92, v92
    v_rcp_f32 v93, v93
    v_rcp_f32 v94, v94
    v_rcp_f32 v95, v95
    v_pk_mul_f32 v[56:57], v[56:57], v[88:89]
    v_pk_mul_f32 v[58:59], v[58:59], v[90:91]
    v_pk_mul_f32 v[60:61], v[60:61], v[92:93]
    v_pk_mul_f32 v[62:63], v[62:63], v[94:95]
    v_pk_add_f32 v[98:99], v[98:99], v[56:57]
    v_pk_fma_f32 v[100:101], v[56:57], v[56:57], v[100:101]
    v_pk_add_f32 v[98:99], v[98:99], v[58:59]
    v_pk_fma_f32 v[100:101], v[58:59], v[58:59], v[100:101]
    v_pk_add_f32 v[98:99], v[98:99], v[60:61]
    v_pk_fma_f32 v[100:101], v[60:61], v[60:61], v[100:101]
    v_pk_add_f32 v[98:99], v[98:99], v[62:63]
    v_pk_fma_f32 v[100:101], v[62:63], v[62:63], v[100:101]
    s_add_u32 s24, s28, 15499264
    s_addc_u32 s25, s29, 0
    s_mov_b32 s26, 921600
    s_mov_b32 s27, 0x00020000
    v_add_f32 v98, v98, v99
    v_add_f32 v100, v100, v101
    v_mul_f32 v98, v98, v25
    v_mul_f32 v100, v100, v25
    v_mul_f32 v100, v100, v25
    v_mov_b32 v99, v98
    v_mov_b32 v101, v100
    v_mov_b32 v103, v25
    s_waitcnt vmcnt(2)
    v_permlane32_swap_b32 v98, v99
    v_permlane32_swap_b32 v100, v101
    s_nop 0
    v_add_f32 v98, v98, v99
    v_add_f32 v100, v100, v101
    s_mov_b32 s5, 65536
recurrent_scan__ssm_conv_h3__mixer_gmlp__prompt_kernel_eppoll1:
    v_readfirstlane_b32 s61, v223
    s_cmp_lg_u32 s61, 0
    s_cbranch_scc1 recurrent_scan__ssm_conv_h3__mixer_gmlp__prompt_kernel_epok2
    s_sub_u32 s5, s5, 1
    s_cmp_eq_u32 s5, 0
    s_cbranch_scc1 recurrent_scan__ssm_conv_h3__mixer_gmlp__prompt_kernel_epok2
    s_sleep 2
    buffer_load_dword v223, v221, s[56:59], 0 offen sc1
    s_waitcnt vmcnt(0)
    s_branch recurrent_scan__ssm_conv_h3__mixer_gmlp__prompt_kernel_eppoll1
recurrent_scan__ssm_conv_h3__mixer_gmlp__prompt_kernel_epok2:
    v_mov_b32 v99, s61
    v_mov_b32 v101, s61
    s_lshl_b32 s4, s33, 2
    s_add_u32 s4, s4, s31
    s_mul_i32 s36, s4, 7168
    s_add_u32 s37, s36, 4096
    s_lshl_b32 s4, s34, 9
    s_add_u32 s4, s4, s36
    v_lshlrev_b32 v97, 4, v1
    s_mov_b32 exec_hi, 0
    buffer_store_dwordx4 v[98:101], v97, s[24:27], s4 offen sc1
    s_mov_b64 exec, -1
    s_barrier
    s_mov_b32 s20, s28
    s_mov_b32 s21, s29
    s_mov_b32 s22, 3670016
    s_mov_b32 s23, 0x00020000
    v_mul_u32_u24 v28, 72, v2
    v_lshl_add_u32 v28, v3, 3, v28
    s_lshl_b32 s4, s31, 14
    v_add_u32 v28, s4, v28
    v_lshrrev_b32 v70, 4, v1
    v_bfe_u32 v65, v1, 2, 2
    v_lshl_add_u32 v70, v70, 3, v65
    v_mul_u32_u24 v70, 72, v70
    v_and_b32 v65, 3, v1
    v_lshl_add_u32 v70, v65, 3, v70
    v_add_u32 v70, s4, v70
    s_lshl_b32 s4, s33, 2
    s_add_u32 s4, s4, s31
    s_mul_i32 s4, s4, 57344
    s_lshl_b32 s5, s34, 12
    s_add_u32 s38, s4, s5
    s_mov_b32 s5, 65536
recurrent_scan__ssm_conv_h3__mixer_gmlp__prompt_kernel_stpoll3:
    buffer_load_dwordx4 v[128:131], v97, s[24:27], s36 offen offset:0 sc1
    buffer_load_dwordx4 v[132:135], v97, s[24:27], s36 offen offset:1024 sc1
    buffer_load_dwordx4 v[136:139], v97, s[24:27], s36 offen offset:2048 sc1
    buffer_load_dwordx4 v[140:143], v97, s[24:27], s36 offen offset:3072 sc1
    buffer_load_dwordx4 v[144:147], v97, s[24:27], s37 offen offset:0 sc1
    buffer_load_dwordx4 v[148:151], v97, s[24:27], s37 offen offset:1024 sc1
    buffer_load_dwordx4 v[152:155], v97, s[24:27], s37 offen offset:2048 sc1
    s_sub_u32 s5, s5, 1
    s_waitcnt vmcnt(0)
    v_max3_u32 v64, v129, v131, v99
    v_min3_u32 v65, v129, v131, v99
    v_max3_u32 v64, v133, v135, v64
    v_min3_u32 v65, v133, v135, v65
    v_max3_u32 v64, v137, v139, v64
    v_min3_u32 v65, v137, v139, v65
    v_max3_u32 v64, v141, v143, v64
    v_min3_u32 v65, v141, v143, v65
    v_max3_u32 v64, v145, v147, v64
    v_min3_u32 v65, v145, v147, v65
    v_max3_u32 v64, v149, v151, v64
    v_min3_u32 v65, v149, v151, v65
    v_max3_u32 v64, v153, v155, v64
    v_min3_u32 v65, v153, v155, v65
    v_cmp_ne_u32 vcc, v64, v65
    s_cmp_eq_u32 s5, 0
    s_cbranch_scc1 recurrent_scan__ssm_conv_h3__mixer_gmlp__prompt_kernel_stok4
    s_nop 2
    s_cbranch_vccz recurrent_scan__ssm_conv_h3__mixer_gmlp__prompt_kernel_stok4
    s_sleep 2
    s_branch recurrent_scan__ssm_conv_h3__mixer_gmlp__prompt_kernel_stpoll3
recurrent_scan__ssm_conv_h3__mixer_gmlp__prompt_kernel_stok4:
    v_add_f32 v128, v128, v132
    v_add_f32 v136, v136, v140
    v_add_f32 v144, v144, v148
    v_add_f32 v128, v128, v152
    v_add_f32 v136, v136, v144
    v_add_f32 v128, v128, v136
    v_mov_b32 v129, v128
    v_add_f32 v130, v130, v134
    v_add_f32 v138, v138, v142
    v_add_f32 v146, v146, v150
    v_add_f32 v130, v130, v154
    v_add_f32 v138, v138, v146
    v_add_f32 v130, v130, v138
    v_mov_b32 v131, v130
    s_nop 1
    v_permlane32_swap_b32 v128, v129
    v_permlane32_swap_b32 v130, v131
    s_nop 0
    v_add_f32 v64, v128, v129
    v_add_f32 v65, v130, v131
    v_mul_f32 v24, 0x3a924925, v64
    v_mul_f32 v66, 0x3a924925, v65
    v_fma_f32 v66, -v24, v24, v66
    v_max_f32 v66, 0, v66
    v_cvt_pk_bf16_f32 v66, v66, v66
    v_lshlrev_b32 v66, 16, v66
    v_add_f32 v66, 0x3727c5ac, v66
    v_cvt_pk_bf16_f32 v66, v66, v66
    v_lshlrev_b32 v66, 16, v66
    v_sqrt_f32 v66, v66
    v_cvt_pk_bf16_f32 v24, v24, v24
    v_lshlrev_b32 v24, 16, v24
    v_cvt_pk_bf16_f32 v66, v66, v66
    v_lshlrev_b32 v66, 16, v66
    v_rcp_f32 v25, v66
    s_nop 0
    v_mul_f32 v24, v24, v25
    v_mul_f32 v25, v25, v103
    v_fma_f32 v32, v32, v25, -v24
    v_fma_f32 v33, v33, v25, -v24
    v_fma_f32 v34, v34, v25, -v24
    v_fma_f32 v35, v35, v25, -v24
    v_cvt_pk_bf16_f32 v66, v32, v33
    v_cvt_pk_bf16_f32 v67, v34, v35
    ds_write_b64 v28, v[66:67] offset:0
    v_fma_f32 v36, v36, v25, -v24
    v_fma_f32 v37, v37, v25, -v24
    v_fma_f32 v38, v38, v25, -v24
    v_fma_f32 v39, v39, v25, -v24
    v_cvt_pk_bf16_f32 v68, v36, v37
    v_cvt_pk_bf16_f32 v69, v38, v39
    ds_write_b64 v28, v[68:69] offset:16
    v_fma_f32 v40, v40, v25, -v24
    v_fma_f32 v41, v41, v25, -v24
    v_fma_f32 v42, v42, v25, -v24
    v_fma_f32 v43, v43, v25, -v24
    v_cvt_pk_bf16_f32 v66, v40, v41
    v_cvt_pk_bf16_f32 v67, v42, v43
    ds_write_b64 v28, v[66:67] offset:32
    v_fma_f32 v44, v44, v25, -v24
    v_fma_f32 v45, v45, v25, -v24
    v_fma_f32 v46, v46, v25, -v24
    v_fma_f32 v47, v47, v25, -v24
    v_cvt_pk_bf16_f32 v68, v44, v45
    v_cvt_pk_bf16_f32 v69, v46, v47
    ds_write_b64 v28, v[68:69] offset:48
    s_waitcnt lgkmcnt(0)
    ds_read_b64_tr_b16 v[128:129], v70 offset:0
    ds_read_b64_tr_b16 v[130:131], v70 offset:288
    ds_read_b64_tr_b16 v[132:133], v70 offset:32
    ds_read_b64_tr_b16 v[134:135], v70 offset:320
    v_fma_f32 v48, v48, v25, -v24
    v_fma_f32 v49, v49, v25, -v24
    v_fma_f32 v50, v50, v25, -v24
    v_fma_f32 v51, v51, v25, -v24
    v_cvt_pk_bf16_f32 v66, v48, v49
    v_cvt_pk_bf16_f32 v67, v50, v51
    ds_write_b64 v28, v[66:67] offset:2304
    v_fma_f32 v52, v52, v25, -v24
    v_fma_f32 v53, v53, v25, -v24
    v_fma_f32 v54, v54, v25, -v24
    v_fma_f32 v55, v55, v25, -v24
    v_cvt_pk_bf16_f32 v68, v52, v53
    v_cvt_pk_bf16_f32 v69, v54, v55
    ds_write_b64 v28, v[68:69] offset:2320
    v_fma_f32 v56, v56, v25, -v24
    v_fma_f32 v57, v57, v25, -v24
    v_fma_f32 v58, v58, v25, -v24
    v_fma_f32 v59, v59, v25, -v24
    v_cvt_pk_bf16_f32 v66, v56, v57
    v_cvt_pk_bf16_f32 v67, v58, v59
    ds_write_b64 v28, v[66:67] offset:2336
    v_fma_f32 v60, v60, v25, -v24
    v_fma_f32 v61, v61, v25, -v24
    v_fma_f32 v62, v62, v25, -v24
    v_fma_f32 v63, v63, v25, -v24
    v_cvt_pk_bf16_f32 v68, v60, v61
    v_cvt_pk_bf16_f32 v69, v62, v63
    ds_write_b64 v28, v[68:69] offset:2352
    s_waitcnt lgkmcnt(0)
    ds_read_b64_tr_b16 v[136:137], v70 offset:2304
    ds_read_b64_tr_b16 v[138:139], v70 offset:2592
    ds_read_b64_tr_b16 v[140:141], v70 offset:2336
    ds_read_b64_tr_b16 v[142:143], v70 offset:2624
    s_waitcnt lgkmcnt(4)
    buffer_store_dwordx4 v[128:131], v97, s[20:23], s38 offen offset:0 sc1
    s_waitcnt lgkmcnt(4)
    buffer_store_dwordx4 v[132:135], v97, s[20:23], s38 offen offset:1024 sc1
    s_waitcnt lgkmcnt(2)
    buffer_store_dwordx4 v[136:139], v97, s[20:23], s38 offen offset:2048 sc1
    s_waitcnt lgkmcnt(0)
    buffer_store_dwordx4 v[140:143], v97, s[20:23], s38 offen offset:3072 sc1
    s_lshl_b32 s88, s34, 11
    s_lshl_b32 s4, s33, 7
    s_add_u32 s88, s88, s4
    s_add_u32 s88, s88, 139264
    s_mov_b32 s63, 1
    s_branch recurrent_scan__ssm_conv_h3__mixer_gmlp__prompt_kernel_p2
recurrent_scan__ssm_conv_h3__mixer_gmlp__prompt_kernel_z1:
    v_add_u32 v16, 98304, v16
    v_add_u32 v17, 98304, v17
    s_mul_i32 s4, s31, 57344
    v_add_u32 v124, s4, v6
    v_add_u32 v125, 28672, v124
    s_lshl_b32 s62, s31, 11
    v_lshrrev_b32 v26, 4, v1
    v_lshl_add_u32 v25, v26, 5, v25
    v_lshlrev_b32 v27, 6, v27
    v_xor_b32 v25, v25, v27
    v_lshl_add_u32 v25, v29, 7, v25
    v_add_u32 v120, s62, v25
    v_add_u32 v121, 0x10000, v120
    v_add_u32 v122, 0x18000, v120
    v_add_u32 v120, 0x4000, v120
    v_and_b32 v29, 15, v1
    v_cmp_eq_u32 vcc, v29, v26
    v_mov_b32 v29, 0x3f803f80
    v_bfe_u32 v25, v1, 2, 1
    v_cndmask_b32 v20, 0, v29, vcc
    v_cndmask_b32 v21, 0, v29, vcc
    v_cndmask_b32 v22, 0, v29, vcc
    v_cndmask_b32 v23, 0, v29, vcc
    v_cmp_eq_u32 vcc, v25, v24
    s_lshl_b32 s4, s31, 2
    s_add_u32 s4, s4, 158720
    v_cndmask_b32 v116, 0, v29, vcc
    v_cndmask_b32 v117, 0, v29, vcc
    v_cndmask_b32 v118, 0, v29, vcc
    v_cndmask_b32 v119, 0, v29, vcc
    v_lshlrev_b32 v123, 4, v1
    v_add_u32 v123, s4, v123
    v_and_b32 v28, 15, v1
    v_lshrrev_b32 v29, 1, v28
    v_xor_b32 v29, v29, v26
    v_lshlrev_b32 v29, 4, v29
    v_lshl_add_u32 v29, v28, 7, v29
    s_lshl_b32 s4, s31, 12
    v_add_u32 v100, s4, v29
    v_xor_b32 v101, 64, v100
    v_add_u32 v104, 0xc000, v100
    v_add_u32 v105, 0xc000, v101
    s_waitcnt vmcnt(3)
    s_barrier
    ds_read_b128 v[128:131], v8 offset:0
    ds_read_b128 v[132:135], v9 offset:0
    ds_read_b128 v[136:139], v10 offset:0
    ds_read_b128 v[140:143], v11 offset:0
    ds_read_b64_tr_b16 v[64:65], v120 offset:0
    ds_read_b64_tr_b16 v[66:67], v120 offset:512
    ds_read_b64_tr_b16 v[68:69], v120 offset:1024
    ds_read_b64_tr_b16 v[70:71], v120 offset:1536
    ds_read_b128 v[80:83], v100 offset:0
    ds_read_b128 v[84:87], v100 offset:2048
    ds_read_b128 v[88:91], v101 offset:0
    ds_read_b128 v[92:95], v101 offset:2048
    s_add_u32 m0, s61, 49152
    s_nop 0
    buffer_load_dwordx4 v4, s[8:11], s18 offen lds
    s_add_u32 m0, s45, 65536
    s_nop 0
    buffer_load_dwordx4 v126, s[12:15], s25 offen lds
    s_add_u32 m0, s61, 50176
    s_nop 0
    buffer_load_dwordx4 v5, s[8:11], s18 offen lds
    s_add_u32 m0, s61, 73728
    s_nop 0
    buffer_load_dwordx4 v4, s[8:11], s19 offen lds
    s_add_u32 m0, s45, 90112
    s_nop 0
    buffer_load_dwordx4 v126, s[12:15], s26 offen lds
    s_add_u32 m0, s61, 74752
    s_nop 0
    buffer_load_dwordx4 v5, s[8:11], s19 offen lds
    s_waitcnt lgkmcnt(0)
    s_waitcnt vmcnt(6)
    s_barrier
    ds_read_b128 v[144:147], v8 offset:24576
    ds_read_b128 v[148:151], v9 offset:24576
    ds_read_b128 v[152:155], v10 offset:24576
    ds_read_b128 v[156:159], v11 offset:24576
    ds_read_b64_tr_b16 v[72:73], v120 offset:24576
    ds_read_b64_tr_b16 v[74:75], v120 offset:25088
    ds_read_b64_tr_b16 v[76:77], v120 offset:25600
    ds_read_b64_tr_b16 v[78:79], v120 offset:26112
    ds_read_b128 v[240:243], v100 offset:24576
    ds_read_b128 v[244:247], v100 offset:26624
    ds_read_b128 v[248:251], v101 offset:24576
    ds_read_b128 v[252:255], v101 offset:26624
    v_mfma_f32_16x16x32_bf16 v[32:35], v[80:83], v[80:83], 0
    s_add_u32 m0, s61, 0
    s_nop 0
    buffer_load_dwordx4 v4, s[8:11], s20 offen lds
    v_mfma_f32_16x16x32_bf16 v[48:51], v[116:119], v[128:131], 0
    v_mfma_f32_16x16x32_bf16 v[24:27], v[20:23], v[64:67], 0
    v_mfma_f32_16x16x32_bf16 v[36:39], v[84:87], v[84:87], 0
    s_add_u32 m0, s45, 16384
    s_nop 0
    buffer_load_dwordx4 v126, s[12:15], s27 offen lds
    v_mfma_f32_16x16x32_bf16 v[48:51], v[116:119], v[132:135], v[48:51]
    v_mfma_f32_16x16x32_bf16 v[24:27], v[20:23], v[68:71], v[24:27]
    v_mfma_f32_16x16x32_bf16 v[32:35], v[88:91], v[88:91], v[32:35]
    s_add_u32 m0, s61, 1024
    s_nop 0
    buffer_load_dwordx4 v5, s[8:11], s20 offen lds
    v_mfma_f32_16x16x32_bf16 v[48:51], v[116:119], v[136:139], v[48:51]
    v_mfma_f32_16x16x32_bf16 v[36:39], v[92:95], v[92:95], v[36:39]
    v_mfma_f32_16x16x32_bf16 v[48:51], v[116:119], v[140:143], v[48:51]
    s_waitcnt lgkmcnt(0)
    s_waitcnt vmcnt(6)
    s_barrier
    ds_read_b128 v[160:163], v12 offset:0
    ds_read_b128 v[164:167], v13 offset:0
    ds_read_b128 v[168:171], v14 offset:0
    ds_read_b128 v[172:175], v15 offset:0
    ds_read_b64_tr_b16 v[64:65], v121 offset:0
    ds_read_b64_tr_b16 v[66:67], v121 offset:512
    ds_read_b64_tr_b16 v[68:69], v121 offset:1024
    ds_read_b64_tr_b16 v[70:71], v121 offset:1536
    ds_read_b128 v[80:83], v104 offset:0
    ds_read_b128 v[84:87], v104 offset:2048
    ds_read_b128 v[88:91], v105 offset:0
    ds_read_b128 v[92:95], v105 offset:2048
    v_mfma_f32_16x16x32_bf16 v[32:35], v[240:243], v[240:243], v[32:35]
    s_add_u32 m0, s61, 24576
    s_nop 0
    buffer_load_dwordx4 v4, s[8:11], s21 offen lds
    v_mfma_f32_16x16x32_bf16 v[48:51], v[116:119], v[144:147], v[48:51]
    v_mfma_f32_16x16x32_bf16 v[24:27], v[20:23], v[72:75], v[24:27]
    v_mfma_f32_16x16x32_bf16 v[36:39], v[244:247], v[244:247], v[36:39]
    s_add_u32 m0, s45, 40960
    s_nop 0
    buffer_load_dwordx4 v126, s[12:15], s46 offen lds
    v_mfma_f32_16x16x32_bf16 v[48:51], v[116:119], v[148:151], v[48:51]
    v_mfma_f32_16x16x32_bf16 v[24:27], v[20:23], v[76:79], v[24:27]
    v_mfma_f32_16x16x32_bf16 v[32:35], v[248:251], v[248:251], v[32:35]
    s_add_u32 m0, s61, 25600
    s_nop 0
    buffer_load_dwordx4 v5, s[8:11], s21 offen lds
    v_mfma_f32_16x16x32_bf16 v[48:51], v[116:119], v[152:155], v[48:51]
    v_mfma_f32_16x16x32_bf16 v[36:39], v[252:255], v[252:255], v[36:39]
    v_mfma_f32_16x16x32_bf16 v[48:51], v[116:119], v[156:159], v[48:51]
    s_waitcnt lgkmcnt(0)
    s_waitcnt vmcnt(6)
    s_barrier
    ds_read_b128 v[176:179], v12 offset:24576
    ds_read_b128 v[180:183], v13 offset:24576
    ds_read_b128 v[184:187], v14 offset:24576
    ds_read_b128 v[188:191], v15 offset:24576
    ds_read_b64_tr_b16 v[72:73], v121 offset:24576
    ds_read_b64_tr_b16 v[74:75], v121 offset:25088
    ds_read_b64_tr_b16 v[76:77], v121 offset:25600
    ds_read_b64_tr_b16 v[78:79], v121 offset:26112
    ds_read_b128 v[240:243], v104 offset:24576
    ds_read_b128 v[244:247], v104 offset:26624
    ds_read_b128 v[248:251], v105 offset:24576
    ds_read_b128 v[252:255], v105 offset:26624
    v_mfma_f32_16x16x32_bf16 v[32:35], v[80:83], v[80:83], v[32:35]
    s_add_u32 m0, s61, 49152
    s_nop 0
    buffer_load_dwordx4 v4, s[8:11], s22 offen lds
    v_mfma_f32_16x16x32_bf16 v[48:51], v[116:119], v[160:163], v[48:51]
    v_mfma_f32_16x16x32_bf16 v[24:27], v[20:23], v[64:67], v[24:27]
    v_mfma_f32_16x16x32_bf16 v[36:39], v[84:87], v[84:87], v[36:39]
    s_add_u32 m0, s45, 65536
    s_nop 0
    buffer_load_dwordx4 v126, s[12:15], s47 offen lds
    v_mfma_f32_16x16x32_bf16 v[48:51], v[116:119], v[164:167], v[48:51]
    v_mfma_f32_16x16x32_bf16 v[24:27], v[20:23], v[68:71], v[24:27]
    v_mfma_f32_16x16x32_bf16 v[32:35], v[88:91], v[88:91], v[32:35]
    s_add_u32 m0, s61, 50176
    s_nop 0
    buffer_load_dwordx4 v5, s[8:11], s22 offen lds
    v_mfma_f32_16x16x32_bf16 v[48:51], v[116:119], v[168:171], v[48:51]
    v_mfma_f32_16x16x32_bf16 v[36:39], v[92:95], v[92:95], v[36:39]
    v_mfma_f32_16x16x32_bf16 v[48:51], v[116:119], v[172:175], v[48:51]
    s_waitcnt lgkmcnt(0)
    s_waitcnt vmcnt(6)
    s_barrier
    ds_read_b128 v[192:195], v8 offset:0
    ds_read_b128 v[196:199], v9 offset:0
    ds_read_b128 v[200:203], v10 offset:0
    ds_read_b128 v[204:207], v11 offset:0
    ds_read_b64_tr_b16 v[64:65], v120 offset:0
    ds_read_b64_tr_b16 v[66:67], v120 offset:512
    ds_read_b64_tr_b16 v[68:69], v120 offset:1024
    ds_read_b64_tr_b16 v[70:71], v120 offset:1536
    ds_read_b128 v[80:83], v100 offset:0
    ds_read_b128 v[84:87], v100 offset:2048
    ds_read_b128 v[88:91], v101 offset:0
    ds_read_b128 v[92:95], v101 offset:2048
    v_mfma_f32_16x16x32_bf16 v[32:35], v[240:243], v[240:243], v[32:35]
    v_mfma_f32_16x16x32_bf16 v[48:51], v[116:119], v[176:179], v[48:51]
    v_mfma_f32_16x16x32_bf16 v[24:27], v[20:23], v[72:75], v[24:27]
    v_mfma_f32_16x16x32_bf16 v[36:39], v[244:247], v[244:247], v[36:39]
    v_mfma_f32_16x16x32_bf16 v[48:51], v[116:119], v[180:183], v[48:51]
    v_mfma_f32_16x16x32_bf16 v[24:27], v[20:23], v[76:79], v[24:27]
    v_mfma_f32_16x16x32_bf16 v[32:35], v[248:251], v[248:251], v[32:35]
    v_mfma_f32_16x16x32_bf16 v[48:51], v[116:119], v[184:187], v[48:51]
    v_mfma_f32_16x16x32_bf16 v[36:39], v[252:255], v[252:255], v[36:39]
    v_mfma_f32_16x16x32_bf16 v[48:51], v[116:119], v[188:191], v[48:51]
    s_waitcnt lgkmcnt(0)
    s_waitcnt vmcnt(3)
    s_barrier
    ds_read_b128 v[208:211], v8 offset:24576
    ds_read_b128 v[212:215], v9 offset:24576
    ds_read_b128 v[216:219], v10 offset:24576
    ds_read_b128 v[220:223], v11 offset:24576
    ds_read_b64_tr_b16 v[72:73], v120 offset:24576
    ds_read_b64_tr_b16 v[74:75], v120 offset:25088
    ds_read_b64_tr_b16 v[76:77], v120 offset:25600
    ds_read_b64_tr_b16 v[78:79], v120 offset:26112
    ds_read_b128 v[240:243], v100 offset:24576
    ds_read_b128 v[244:247], v100 offset:26624
    ds_read_b128 v[248:251], v101 offset:24576
    ds_read_b128 v[252:255], v101 offset:26624
    v_mfma_f32_16x16x32_bf16 v[32:35], v[80:83], v[80:83], v[32:35]
    s_add_u32 m0, s62, 98304
    s_nop 0
    buffer_load_dwordx4 v124, s[12:15], s23 offen lds
    v_mfma_f32_16x16x32_bf16 v[48:51], v[116:119], v[192:195], v[48:51]
    v_mfma_f32_16x16x32_bf16 v[24:27], v[20:23], v[64:67], v[24:27]
    v_mfma_f32_16x16x32_bf16 v[36:39], v[84:87], v[84:87], v[36:39]
    s_add_u32 m0, s62, 99328
    s_nop 0
    buffer_load_dwordx4 v125, s[12:15], s23 offen lds
    v_mfma_f32_16x16x32_bf16 v[48:51], v[116:119], v[196:199], v[48:51]
    v_mfma_f32_16x16x32_bf16 v[24:27], v[20:23], v[68:71], v[24:27]
    v_mfma_f32_16x16x32_bf16 v[32:35], v[88:91], v[88:91], v[32:35]
    s_add_u32 m0, s62, 106496
    s_nop 0
    buffer_load_dwordx4 v124, s[12:15], s24 offen lds
    v_mfma_f32_16x16x32_bf16 v[48:51], v[116:119], v[200:203], v[48:51]
    v_mfma_f32_16x16x32_bf16 v[36:39], v[92:95], v[92:95], v[36:39]
    s_add_u32 m0, s62, 107520
    s_nop 0
    buffer_load_dwordx4 v125, s[12:15], s24 offen lds
    v_mfma_f32_16x16x32_bf16 v[48:51], v[116:119], v[204:207], v[48:51]
    s_waitcnt lgkmcnt(0)
    s_waitcnt vmcnt(4)
    s_barrier
    ds_read_b128 v[224:227], v12 offset:0
    ds_read_b128 v[228:231], v13 offset:0
    ds_read_b128 v[232:235], v14 offset:0
    ds_read_b128 v[236:239], v15 offset:0
    ds_read_b64_tr_b16 v[64:65], v121 offset:0
    ds_read_b64_tr_b16 v[66:67], v121 offset:512
    ds_read_b64_tr_b16 v[68:69], v121 offset:1024
    ds_read_b64_tr_b16 v[70:71], v121 offset:1536
    ds_read_b128 v[80:83], v104 offset:0
    ds_read_b128 v[84:87], v104 offset:2048
    ds_read_b128 v[88:91], v105 offset:0
    ds_read_b128 v[92:95], v105 offset:2048
    v_mfma_f32_16x16x32_bf16 v[32:35], v[240:243], v[240:243], v[32:35]
    s_add_u32 m0, s62, 114688
    s_nop 0
    buffer_load_dwordx4 v124, s[12:15], s25 offen lds
    v_mfma_f32_16x16x32_bf16 v[48:51], v[116:119], v[208:211], v[48:51]
    v_mfma_f32_16x16x32_bf16 v[24:27], v[20:23], v[72:75], v[24:27]
    v_mfma_f32_16x16x32_bf16 v[36:39], v[244:247], v[244:247], v[36:39]
    s_add_u32 m0, s62, 115712
    s_nop 0
    buffer_load_dwordx4 v125, s[12:15], s25 offen lds
    v_mfma_f32_16x16x32_bf16 v[48:51], v[116:119], v[212:215], v[48:51]
    v_mfma_f32_16x16x32_bf16 v[24:27], v[20:23], v[76:79], v[24:27]
    v_mfma_f32_16x16x32_bf16 v[32:35], v[248:251], v[248:251], v[32:35]
    s_add_u32 m0, s62, 122880
    s_nop 0
    buffer_load_dwordx4 v124, s[12:15], s26 offen lds
    v_mfma_f32_16x16x32_bf16 v[48:51], v[116:119], v[216:219], v[48:51]
    v_mfma_f32_16x16x32_bf16 v[36:39], v[252:255], v[252:255], v[36:39]
    s_add_u32 m0, s62, 123904
    s_nop 0
    buffer_load_dwordx4 v125, s[12:15], s26 offen lds
    v_mfma_f32_16x16x32_bf16 v[48:51], v[116:119], v[220:223], v[48:51]
    s_waitcnt lgkmcnt(0)
    v_mfma_f32_16x16x32_bf16 v[32:35], v[80:83], v[80:83], v[32:35]
    v_mfma_f32_16x16x32_bf16 v[48:51], v[116:119], v[224:227], v[48:51]
    v_mfma_f32_16x16x32_bf16 v[24:27], v[20:23], v[64:67], v[24:27]
    v_mfma_f32_16x16x32_bf16 v[36:39], v[84:87], v[84:87], v[36:39]
    v_mfma_f32_16x16x32_bf16 v[48:51], v[116:119], v[228:231], v[48:51]
    v_mfma_f32_16x16x32_bf16 v[24:27], v[20:23], v[68:71], v[24:27]
    v_mfma_f32_16x16x32_bf16 v[32:35], v[88:91], v[88:91], v[32:35]
    v_mfma_f32_16x16x32_bf16 v[48:51], v[116:119], v[232:235], v[48:51]
    v_mfma_f32_16x16x32_bf16 v[36:39], v[92:95], v[92:95], v[36:39]
    v_mfma_f32_16x16x32_bf16 v[48:51], v[116:119], v[236:239], v[48:51]
    s_mov_b64 exec, 0xffff
    s_nop 2
    ds_write_b32 v123, v24 offset:0
    ds_write_b32 v123, v25 offset:256
    ds_write_b32 v123, v26 offset:512
    ds_write_b32 v123, v27 offset:768
    s_mov_b64 exec, -1
    s_nop 7
    s_mov_b32 vcc_lo, 0xaaaaaaaa
    s_mov_b32 vcc_hi, 0xaaaaaaaa
    v_cndmask_b32 v32, v32, v33, vcc
    v_cndmask_b32 v34, v34, v35, vcc
    v_cndmask_b32 v36, v36, v37, vcc
    v_cndmask_b32 v38, v38, v39, vcc
    s_mov_b32 vcc_lo, 0xcccccccc
    s_mov_b32 vcc_hi, 0xcccccccc
    v_cndmask_b32 v32, v32, v34, vcc
    v_cndmask_b32 v36, v36, v38, vcc
    v_and_b32 v28, 15, v1
    v_lshrrev_b32 v29, 2, v28
    v_lshl_add_u32 v28, v29, 4, v28
    v_lshlrev_b32 v28, 2, v28
    ds_bpermute_b32 v30, v28, v32
    ds_bpermute_b32 v31, v28, v36
    s_mov_b32 vcc_lo, 0xffff0000
    s_mov_b32 vcc_hi, 0xffff0000
    s_waitcnt lgkmcnt(0)
    v_cndmask_b32 v30, v30, v31, vcc
    v_mul_f32 v30, 0.5, v30
    v_mov_b32 v31, v30
    s_lshl_b32 s4, s31, 8
    s_add_u32 s5, s4, 155648
    v_permlane32_swap_b32 v30, v31
    v_lshlrev_b32 v96, 3, v2
    v_add_u32 v97, s5, v96
    v_add_f32 v30, v30, v31
    v_mul_f32 v98, 0x3b124925, v48
    v_mul_f32 v29, 0x3b124925, v30
    v_fma_f32 v29, -v98, v98, v29
    v_max_f32 v29, 0, v29
    v_cvt_pk_bf16_f32 v29, v29, v29
    v_lshlrev_b32 v29, 16, v29
    v_add_f32 v29, 0x3727c5ac, v29
    v_cvt_pk_bf16_f32 v29, v29, v29
    v_lshlrev_b32 v29, 16, v29
    v_sqrt_f32 v29, v29
    v_cvt_pk_bf16_f32 v98, v98, v98
    v_lshlrev_b32 v98, 16, v98
    v_cvt_pk_bf16_f32 v29, v29, v29
    v_lshlrev_b32 v29, 16, v29
    v_rcp_f32 v99, v29
    s_nop 0
    ds_write_b64 v97, v[98:99]
    s_waitcnt lgkmcnt(0)
    s_barrier
    s_add_u32 m0, s62, 131072
    s_nop 0
    buffer_load_dwordx4 v124, s[12:15], s27 offen lds
    s_add_u32 m0, s62, 132096
    s_nop 0
    buffer_load_dwordx4 v125, s[12:15], s27 offen lds
    s_add_u32 m0, s62, 139264
    s_nop 0
    buffer_load_dwordx4 v124, s[12:15], s46 offen lds
    s_add_u32 m0, s62, 140288
    s_nop 0
    buffer_load_dwordx4 v125, s[12:15], s46 offen lds
    s_add_u32 m0, s62, 147456
    s_nop 0
    buffer_load_dwordx4 v124, s[12:15], s47 offen lds
    s_add_u32 m0, s62, 148480
    s_nop 0
    buffer_load_dwordx4 v125, s[12:15], s47 offen lds
    s_mul_i32 s52, s33, 14
    s_add_u32 s52, s52, s34
    s_cmp_ge_u32 s52, 196
    s_cbranch_scc1 recurrent_scan__ssm_conv_h3__mixer_gmlp__prompt_kernel_nowof5
    s_mov_b32 s56, s48
    s_mov_b32 s57, s49
    s_mov_b32 s58, 802816
    s_mov_b32 s59, 0x00020000
    s_mul_i32 s53, s52, 9363
    s_lshr_b32 s53, s53, 16
    s_mul_i32 s54, s53, 7
    s_sub_u32 s54, s52, s54
    s_lshl_b32 s54, s54, 2
    s_add_u32 s54, s54, s31
    v_lshrrev_b32 v30, 1, v1
    v_mul_u32_u24 v30, 896, v30
    v_and_b32 v31, 1, v1
    v_lshl_add_u32 v30, v31, 4, v30
    s_mul_i32 s55, s53, 28672
    s_lshl_b32 s5, s54, 5
    s_add_u32 s55, s55, s5
    s_lshl_b32 s5, s31, 10
    s_add_u32 s5, s5, 73728
    s_mov_b32 m0, s5
    v_lshlrev_b32 v31, 3, v1
    buffer_load_dwordx4 v30, s[56:59], s55 offen lds
    v_add_u32 v31, s5, v31
recurrent_scan__ssm_conv_h3__mixer_gmlp__prompt_kernel_nowof5:
    s_cmp_lg_u32 s34, 0
    s_cbranch_scc1 recurrent_scan__ssm_conv_h3__mixer_gmlp__prompt_kernel_nost6
    s_add_u32 s36, s28, 15482880
    s_addc_u32 s37, s29, 0
    s_mov_b32 s38, 16384
    s_mov_b32 s39, 0x00020000
    s_lshl_b32 s5, s33, 10
    s_add_u32 s4, s4, s5
    s_mov_b32 exec_hi, 0
    buffer_store_dwordx2 v[98:99], v96, s[36:39], s4 offen sc1
    s_mov_b64 exec, -1
recurrent_scan__ssm_conv_h3__mixer_gmlp__prompt_kernel_nost6:
    s_waitcnt vmcnt(0)
    s_cmp_ge_u32 s52, 196
    s_cbranch_scc1 recurrent_scan__ssm_conv_h3__mixer_gmlp__prompt_kernel_nowof27
    s_add_u32 s56, s28, 11010048
    s_addc_u32 s57, s29, 0
    s_mov_b32 s58, 802816
    s_mov_b32 s59, 0x00020000
    ds_read_b64_tr_b16 v[240:241], v31
    ds_read_b64_tr_b16 v[242:243], v31 offset:512
    s_mul_i32 s55, s54, 28672
    s_lshl_b32 s5, s53, 10
    s_add_u32 s55, s55, s5
    v_lshlrev_b32 v30, 4, v1
    s_waitcnt lgkmcnt(0)
    buffer_store_dwordx4 v[240:243], v30, s[56:59], s55 offen sc1
recurrent_scan__ssm_conv_h3__mixer_gmlp__prompt_kernel_nowof27:
    ds_read_b64_tr_b16 v[32:33], v122 offset:0
    ds_read_b64_tr_b16 v[34:35], v122 offset:512
    ds_read_b64_tr_b16 v[36:37], v122 offset:1024
    ds_read_b64_tr_b16 v[38:39], v122 offset:1536
    ds_read_b64_tr_b16 v[40:41], v122 offset:8192
    ds_read_b64_tr_b16 v[42:43], v122 offset:8704
    ds_read_b64_tr_b16 v[44:45], v122 offset:9216
    ds_read_b64_tr_b16 v[46:47], v122 offset:9728
    ds_read_b64_tr_b16 v[48:49], v122 offset:16384
    ds_read_b64_tr_b16 v[50:51], v122 offset:16896
    ds_read_b64_tr_b16 v[52:53], v122 offset:17408
    ds_read_b64_tr_b16 v[54:55], v122 offset:17920
    ds_read_b64_tr_b16 v[56:57], v122 offset:24576
    ds_read_b64_tr_b16 v[58:59], v122 offset:25088
    ds_read_b64_tr_b16 v[60:61], v122 offset:25600
    ds_read_b64_tr_b16 v[62:63], v122 offset:26112
    s_waitcnt lgkmcnt(0)
    v_mfma_f32_16x16x32_bf16 v[24:27], v[20:23], v[32:35], 0
    v_mfma_f32_16x16x32_bf16 v[24:27], v[20:23], v[36:39], v[24:27]
    v_mfma_f32_16x16x32_bf16 v[24:27], v[20:23], v[40:43], v[24:27]
    v_mfma_f32_16x16x32_bf16 v[24:27], v[20:23], v[44:47], v[24:27]
    v_mfma_f32_16x16x32_bf16 v[24:27], v[20:23], v[48:51], v[24:27]
    v_mfma_f32_16x16x32_bf16 v[24:27], v[20:23], v[52:55], v[24:27]
    v_mfma_f32_16x16x32_bf16 v[24:27], v[20:23], v[56:59], v[24:27]
    v_mfma_f32_16x16x32_bf16 v[24:27], v[20:23], v[60:63], v[24:27]
    ds_read_b64_tr_b16 v[32:33], v122 offset:32768
    ds_read_b64_tr_b16 v[34:35], v122 offset:33280
    ds_read_b64_tr_b16 v[36:37], v122 offset:33792
    ds_read_b64_tr_b16 v[38:39], v122 offset:34304
    ds_read_b64_tr_b16 v[40:41], v122 offset:40960
    ds_read_b64_tr_b16 v[42:43], v122 offset:41472
    ds_read_b64_tr_b16 v[44:45], v122 offset:41984
    ds_read_b64_tr_b16 v[46:47], v122 offset:42496
    ds_read_b64_tr_b16 v[48:49], v122 offset:49152
    ds_read_b64_tr_b16 v[50:51], v122 offset:49664
    ds_read_b64_tr_b16 v[52:53], v122 offset:50176
    ds_read_b64_tr_b16 v[54:55], v122 offset:50688
    s_waitcnt lgkmcnt(0)
    v_mfma_f32_16x16x32_bf16 v[24:27], v[20:23], v[32:35], v[24:27]
    v_mfma_f32_16x16x32_bf16 v[24:27], v[20:23], v[36:39], v[24:27]
    v_mfma_f32_16x16x32_bf16 v[24:27], v[20:23], v[40:43], v[24:27]
    v_mfma_f32_16x16x32_bf16 v[24:27], v[20:23], v[44:47], v[24:27]
    v_mfma_f32_16x16x32_bf16 v[24:27], v[20:23], v[48:51], v[24:27]
    v_mfma_f32_16x16x32_bf16 v[24:27], v[20:23], v[52:55], v[24:27]
    s_mov_b64 exec, 0xffff
    s_nop 7
    ds_write_b32 v123, v24 offset:1024
    ds_write_b32 v123, v25 offset:1280
    ds_write_b32 v123, v26 offset:1536
    ds_write_b32 v123, v27 offset:1792
    s_mov_b64 exec, -1
    s_waitcnt lgkmcnt(0)
    s_barrier
    ds_read_b64_tr_b16 v[100:101], v16 offset:0
    ds_read_b64_tr_b16 v[102:103], v16 offset:512
    ds_read_b64_tr_b16 v[104:105], v17 offset:0
    ds_read_b64_tr_b16 v[106:107], v17 offset:512
    ds_read_b64_tr_b16 v[108:109], v16 offset:2048
    ds_read_b64_tr_b16 v[110:111], v16 offset:2560
    ds_read_b64_tr_b16 v[112:113], v17 offset:2048
    ds_read_b64_tr_b16 v[114:115], v17 offset:2560
    ds_read_b64_tr_b16 v[116:117], v16 offset:4096
    ds_read_b64_tr_b16 v[118:119], v16 offset:4608
    ds_read_b64_tr_b16 v[120:121], v17 offset:4096
    ds_read_b64_tr_b16 v[122:123], v17 offset:4608
    s_waitcnt lgkmcnt(8)
    v_mfma_f32_32x32x16_bf16 v[32:47], v[100:103], v[128:131], 0
    v_mfma_f32_32x32x16_bf16 v[48:63], v[104:107], v[128:131], 0
    ds_read_b64_tr_b16 v[100:101], v16 offset:6144
    ds_read_b64_tr_b16 v[102:103], v16 offset:6656
    ds_read_b64_tr_b16 v[104:105], v17 offset:6144
    ds_read_b64_tr_b16 v[106:107], v17 offset:6656
    s_waitcnt lgkmcnt(8)
    v_mfma_f32_32x32x16_bf16 v[32:47], v[108:111], v[132:135], v[32:47]
    v_mfma_f32_32x32x16_bf16 v[48:63], v[112:115], v[132:135], v[48:63]
    v_lshlrev_b32 v96, 4, v1
    v_add_u32 v96, 159744, v96
    ds_read_b128 v[64:67], v96
    s_lshl_b32 s4, s30, 8
    s_add_u32 s4, s4, 156672
    v_lshlrev_b32 v96, 2, v1
    v_add_u32 v96, s4, v96
    v_lshlrev_b32 v97, 4, v3
    v_add_u32 v97, s4, v97
    s_waitcnt lgkmcnt(0)
    v_add_f32 v64, v64, v65
    v_add_f32 v66, v66, v67
    v_add_f32 v64, v64, v66
    ds_write_b32 v96, v64
    s_waitcnt lgkmcnt(0)
    ds_read_b128 v[64:67], v97 offset:0
    ds_read_b128 v[68:71], v97 offset:32
    ds_read_b128 v[72:75], v97 offset:64
    ds_read_b128 v[76:79], v97 offset:96
    ds_read_b128 v[80:83], v97 offset:128
    ds_read_b128 v[84:87], v97 offset:160
    ds_read_b128 v[88:91], v97 offset:192
    ds_read_b128 v[92:95], v97 offset:224
    ds_read_b64_tr_b16 v[108:109], v16 offset:8192
    ds_read_b64_tr_b16 v[110:111], v16 offset:8704
    ds_read_b64_tr_b16 v[112:113], v17 offset:8192
    ds_read_b64_tr_b16 v[114:115], v17 offset:8704
    s_waitcnt lgkmcnt(12)
    v_mfma_f32_32x32x16_bf16 v[32:47], v[116:119], v[136:139], v[32:47]
    v_mfma_f32_32x32x16_bf16 v[48:63], v[120:123], v[136:139], v[48:63]
    ds_read_b64_tr_b16 v[116:117], v16 offset:10240
    ds_read_b64_tr_b16 v[118:119], v16 offset:10752
    ds_read_b64_tr_b16 v[120:121], v17 offset:10240
    ds_read_b64_tr_b16 v[122:123], v17 offset:10752
    s_waitcnt lgkmcnt(8)
    v_mfma_f32_32x32x16_bf16 v[32:47], v[100:103], v[140:143], v[32:47]
    v_mfma_f32_32x32x16_bf16 v[48:63], v[104:107], v[140:143], v[48:63]
    ds_read_b64_tr_b16 v[100:101], v16 offset:12288
    ds_read_b64_tr_b16 v[102:103], v16 offset:12800
    ds_read_b64_tr_b16 v[104:105], v17 offset:12288
    ds_read_b64_tr_b16 v[106:107], v17 offset:12800
    s_waitcnt lgkmcnt(8)
    v_mfma_f32_32x32x16_bf16 v[32:47], v[108:111], v[144:147], v[32:47]
    v_mfma_f32_32x32x16_bf16 v[48:63], v[112:115], v[144:147], v[48:63]
    ds_read_b64_tr_b16 v[108:109], v16 offset:14336
    ds_read_b64_tr_b16 v[110:111], v16 offset:14848
    ds_read_b64_tr_b16 v[112:113], v17 offset:14336
    ds_read_b64_tr_b16 v[114:115], v17 offset:14848
    s_waitcnt lgkmcnt(8)
    v_mfma_f32_32x32x16_bf16 v[32:47], v[116:119], v[148:151], v[32:47]
    v_mfma_f32_32x32x16_bf16 v[48:63], v[120:123], v[148:151], v[48:63]
    ds_read_b64_tr_b16 v[116:117], v16 offset:16384
    ds_read_b64_tr_b16 v[118:119], v16 offset:16896
    ds_read_b64_tr_b16 v[120:121], v17 offset:16384
    ds_read_b64_tr_b16 v[122:123], v17 offset:16896
    s_waitcnt lgkmcnt(8)
    v_mfma_f32_32x32x16_bf16 v[32:47], v[100:103], v[152:155], v[32:47]
    v_mfma_f32_32x32x16_bf16 v[48:63], v[104:107], v[152:155], v[48:63]
    ds_read_b64_tr_b16 v[100:101], v16 offset:18432
    ds_read_b64_tr_b16 v[102:103], v16 offset:18944
    ds_read_b64_tr_b16 v[104:105], v17 offset:18432
    ds_read_b64_tr_b16 v[106:107], v17 offset:18944
    s_waitcnt lgkmcnt(8)
    v_mfma_f32_32x32x16_bf16 v[32:47], v[108:111], v[156:159], v[32:47]
    v_mfma_f32_32x32x16_bf16 v[48:63], v[112:115], v[156:159], v[48:63]
    ds_read_b64_tr_b16 v[108:109], v16 offset:20480
    ds_read_b64_tr_b16 v[110:111], v16 offset:20992
    ds_read_b64_tr_b16 v[112:113], v17 offset:20480
    ds_read_b64_tr_b16 v[114:115], v17 offset:20992
    s_waitcnt lgkmcnt(8)
    v_mfma_f32_32x32x16_bf16 v[32:47], v[116:119], v[160:163], v[32:47]
    v_mfma_f32_32x32x16_bf16 v[48:63], v[120:123], v[160:163], v[48:63]
    ds_read_b64_tr_b16 v[116:117], v16 offset:22528
    ds_read_b64_tr_b16 v[118:119], v16 offset:23040
    ds_read_b64_tr_b16 v[120:121], v17 offset:22528
    ds_read_b64_tr_b16 v[122:123], v17 offset:23040
    s_waitcnt lgkmcnt(8)
    v_mfma_f32_32x32x16_bf16 v[32:47], v[100:103], v[164:167], v[32:47]
    v_mfma_f32_32x32x16_bf16 v[48:63], v[104:107], v[164:167], v[48:63]
    ds_read_b64_tr_b16 v[100:101], v16 offset:24576
    ds_read_b64_tr_b16 v[102:103], v16 offset:25088
    ds_read_b64_tr_b16 v[104:105], v17 offset:24576
    ds_read_b64_tr_b16 v[106:107], v17 offset:25088
    s_waitcnt lgkmcnt(8)
    v_mfma_f32_32x32x16_bf16 v[32:47], v[108:111], v[168:171], v[32:47]
    v_mfma_f32_32x32x16_bf16 v[48:63], v[112:115], v[168:171], v[48:63]
    ds_read_b64_tr_b16 v[108:109], v16 offset:26624
    ds_read_b64_tr_b16 v[110:111], v16 offset:27136
    ds_read_b64_tr_b16 v[112:113], v17 offset:26624
    ds_read_b64_tr_b16 v[114:115], v17 offset:27136
    s_waitcnt lgkmcnt(8)
    v_mfma_f32_32x32x16_bf16 v[32:47], v[116:119], v[172:175], v[32:47]
    v_mfma_f32_32x32x16_bf16 v[48:63], v[120:123], v[172:175], v[48:63]
    ds_read_b64_tr_b16 v[116:117], v16 offset:28672
    ds_read_b64_tr_b16 v[118:119], v16 offset:29184
    ds_read_b64_tr_b16 v[120:121], v17 offset:28672
    ds_read_b64_tr_b16 v[122:123], v17 offset:29184
    s_waitcnt lgkmcnt(8)
    v_mfma_f32_32x32x16_bf16 v[32:47], v[100:103], v[176:179], v[32:47]
    v_mfma_f32_32x32x16_bf16 v[48:63], v[104:107], v[176:179], v[48:63]
    ds_read_b64_tr_b16 v[100:101], v16 offset:30720
    ds_read_b64_tr_b16 v[102:103], v16 offset:31232
    ds_read_b64_tr_b16 v[104:105], v17 offset:30720
    ds_read_b64_tr_b16 v[106:107], v17 offset:31232
    s_waitcnt lgkmcnt(8)
    v_mfma_f32_32x32x16_bf16 v[32:47], v[108:111], v[180:183], v[32:47]
    v_mfma_f32_32x32x16_bf16 v[48:63], v[112:115], v[180:183], v[48:63]
    ds_read_b64_tr_b16 v[108:109], v16 offset:32768
    ds_read_b64_tr_b16 v[110:111], v16 offset:33280
    ds_read_b64_tr_b16 v[112:113], v17 offset:32768
    ds_read_b64_tr_b16 v[114:115], v17 offset:33280
    s_waitcnt lgkmcnt(8)
    v_mfma_f32_32x32x16_bf16 v[32:47], v[116:119], v[184:187], v[32:47]
    v_mfma_f32_32x32x16_bf16 v[48:63], v[120:123], v[184:187], v[48:63]
    ds_read_b64_tr_b16 v[116:117], v16 offset:34816
    ds_read_b64_tr_b16 v[118:119], v16 offset:35328
    ds_read_b64_tr_b16 v[120:121], v17 offset:34816
    ds_read_b64_tr_b16 v[122:123], v17 offset:35328
    s_waitcnt lgkmcnt(8)
    v_mfma_f32_32x32x16_bf16 v[32:47], v[100:103], v[188:191], v[32:47]
    v_mfma_f32_32x32x16_bf16 v[48:63], v[104:107], v[188:191], v[48:63]
    ds_read_b64_tr_b16 v[100:101], v16 offset:36864
    ds_read_b64_tr_b16 v[102:103], v16 offset:37376
    ds_read_b64_tr_b16 v[104:105], v17 offset:36864
    ds_read_b64_tr_b16 v[106:107], v17 offset:37376
    s_waitcnt lgkmcnt(8)
    v_mfma_f32_32x32x16_bf16 v[32:47], v[108:111], v[192:195], v[32:47]
    v_mfma_f32_32x32x16_bf16 v[48:63], v[112:115], v[192:195], v[48:63]
    ds_read_b64_tr_b16 v[108:109], v16 offset:38912
    ds_read_b64_tr_b16 v[110:111], v16 offset:39424
    ds_read_b64_tr_b16 v[112:113], v17 offset:38912
    ds_read_b64_tr_b16 v[114:115], v17 offset:39424
    s_waitcnt lgkmcnt(8)
    v_mfma_f32_32x32x16_bf16 v[32:47], v[116:119], v[196:199], v[32:47]
    v_mfma_f32_32x32x16_bf16 v[48:63], v[120:123], v[196:199], v[48:63]
    ds_read_b64_tr_b16 v[116:117], v16 offset:40960
    ds_read_b64_tr_b16 v[118:119], v16 offset:41472
    ds_read_b64_tr_b16 v[120:121], v17 offset:40960
    ds_read_b64_tr_b16 v[122:123], v17 offset:41472
    s_waitcnt lgkmcnt(8)
    v_mfma_f32_32x32x16_bf16 v[32:47], v[100:103], v[200:203], v[32:47]
    v_mfma_f32_32x32x16_bf16 v[48:63], v[104:107], v[200:203], v[48:63]
    ds_read_b64_tr_b16 v[100:101], v16 offset:43008
    ds_read_b64_tr_b16 v[102:103], v16 offset:43520
    ds_read_b64_tr_b16 v[104:105], v17 offset:43008
    ds_read_b64_tr_b16 v[106:107], v17 offset:43520
    s_waitcnt lgkmcnt(8)
    v_mfma_f32_32x32x16_bf16 v[32:47], v[108:111], v[204:207], v[32:47]
    v_mfma_f32_32x32x16_bf16 v[48:63], v[112:115], v[204:207], v[48:63]
    ds_read_b64_tr_b16 v[108:109], v16 offset:45056
    ds_read_b64_tr_b16 v[110:111], v16 offset:45568
    ds_read_b64_tr_b16 v[112:113], v17 offset:45056
    ds_read_b64_tr_b16 v[114:115], v17 offset:45568
    s_waitcnt lgkmcnt(8)
    v_mfma_f32_32x32x16_bf16 v[32:47], v[116:119], v[208:211], v[32:47]
    v_mfma_f32_32x32x16_bf16 v[48:63], v[120:123], v[208:211], v[48:63]
    ds_read_b64_tr_b16 v[116:117], v16 offset:47104
    ds_read_b64_tr_b16 v[118:119], v16 offset:47616
    ds_read_b64_tr_b16 v[120:121], v17 offset:47104
    ds_read_b64_tr_b16 v[122:123], v17 offset:47616
    s_waitcnt lgkmcnt(8)
    v_mfma_f32_32x32x16_bf16 v[32:47], v[100:103], v[212:215], v[32:47]
    v_mfma_f32_32x32x16_bf16 v[48:63], v[104:107], v[212:215], v[48:63]
    ds_read_b64_tr_b16 v[100:101], v16 offset:49152
    ds_read_b64_tr_b16 v[102:103], v16 offset:49664
    ds_read_b64_tr_b16 v[104:105], v17 offset:49152
    ds_read_b64_tr_b16 v[106:107], v17 offset:49664
    s_waitcnt lgkmcnt(8)
    v_mfma_f32_32x32x16_bf16 v[32:47], v[108:111], v[216:219], v[32:47]
    v_mfma_f32_32x32x16_bf16 v[48:63], v[112:115], v[216:219], v[48:63]
    ds_read_b64_tr_b16 v[108:109], v16 offset:51200
    ds_read_b64_tr_b16 v[110:111], v16 offset:51712
    ds_read_b64_tr_b16 v[112:113], v17 offset:51200
    ds_read_b64_tr_b16 v[114:115], v17 offset:51712
    s_waitcnt lgkmcnt(8)
    v_mfma_f32_32x32x16_bf16 v[32:47], v[116:119], v[220:223], v[32:47]
    v_mfma_f32_32x32x16_bf16 v[48:63], v[120:123], v[220:223], v[48:63]
    ds_read_b64_tr_b16 v[116:117], v16 offset:53248
    ds_read_b64_tr_b16 v[118:119], v16 offset:53760
    ds_read_b64_tr_b16 v[120:121], v17 offset:53248
    ds_read_b64_tr_b16 v[122:123], v17 offset:53760
    s_waitcnt lgkmcnt(8)
    v_mfma_f32_32x32x16_bf16 v[32:47], v[100:103], v[224:227], v[32:47]
    v_mfma_f32_32x32x16_bf16 v[48:63], v[104:107], v[224:227], v[48:63]
    ds_read_b64_tr_b16 v[100:101], v16 offset:55296
    ds_read_b64_tr_b16 v[102:103], v16 offset:55808
    ds_read_b64_tr_b16 v[104:105], v17 offset:55296
    ds_read_b64_tr_b16 v[106:107], v17 offset:55808
    s_waitcnt lgkmcnt(8)
    v_mfma_f32_32x32x16_bf16 v[32:47], v[108:111], v[228:231], v[32:47]
    v_mfma_f32_32x32x16_bf16 v[48:63], v[112:115], v[228:231], v[48:63]
    s_waitcnt lgkmcnt(4)
    v_mfma_f32_32x32x16_bf16 v[32:47], v[116:119], v[232:235], v[32:47]
    v_mfma_f32_32x32x16_bf16 v[48:63], v[120:123], v[232:235], v[48:63]
    s_waitcnt lgkmcnt(0)
    v_mfma_f32_32x32x16_bf16 v[32:47], v[100:103], v[236:239], v[32:47]
    v_mfma_f32_32x32x16_bf16 v[48:63], v[104:107], v[236:239], v[48:63]
    v_mov_b32 v28, 163328
    v_mov_b32 v29, 1
    s_mov_b64 exec, 1
    ds_add_u32 v28, v29 offset:32
    s_mov_b64 exec, -1
    s_setprio 3
    s_add_u32 s16, s28, 3670016
    s_addc_u32 s17, s29, 0
    s_mov_b32 s18, 3670016
    s_mov_b32 s19, 0x00020000
    v_sub_f32 v24, 0, v98
    v_sub_f32 v25, 0, v98
    v_mov_b32 v26, v99
    v_mov_b32 v27, v99
    v_bfe_u32 v28, v1, 4, 1
    v_mul_u32_u24 v28, 28672, v28
    v_and_b32 v29, 15, v1
    v_lshl_add_u32 v29, v3, 4, v29
    v_lshl_add_u32 v28, v29, 4, v28
    s_lshl_b32 s4, s33, 2
    s_add_u32 s4, s4, s31
    s_mul_i32 s4, s4, 57344
    s_lshl_b32 s5, s34, 11
    s_add_u32 s4, s4, s5
    s_waitcnt lgkmcnt(0)
    v_pk_fma_f32 v[32:33], v[24:25], v[64:65], v[32:33]
    v_pk_mul_f32 v[32:33], v[32:33], v[26:27]
    v_cvt_pk_bf16_f32 v100, v32, v33
    v_pk_fma_f32 v[34:35], v[24:25], v[66:67], v[34:35]
    v_pk_mul_f32 v[34:35], v[34:35], v[26:27]
    v_cvt_pk_bf16_f32 v101, v34, v35
    v_pk_fma_f32 v[36:37], v[24:25], v[68:69], v[36:37]
    v_pk_mul_f32 v[36:37], v[36:37], v[26:27]
    v_cvt_pk_bf16_f32 v104, v36, v37
    v_pk_fma_f32 v[38:39], v[24:25], v[70:71], v[38:39]
    v_pk_mul_f32 v[38:39], v[38:39], v[26:27]
    v_cvt_pk_bf16_f32 v105, v38, v39
    v_pk_fma_f32 v[40:41], v[24:25], v[72:73], v[40:41]
    v_pk_mul_f32 v[40:41], v[40:41], v[26:27]
    v_cvt_pk_bf16_f32 v102, v40, v41
    v_pk_fma_f32 v[42:43], v[24:25], v[74:75], v[42:43]
    v_pk_mul_f32 v[42:43], v[42:43], v[26:27]
    v_cvt_pk_bf16_f32 v103, v42, v43
    v_pk_fma_f32 v[44:45], v[24:25], v[76:77], v[44:45]
    v_pk_mul_f32 v[44:45], v[44:45], v[26:27]
    v_cvt_pk_bf16_f32 v106, v44, v45
    v_pk_fma_f32 v[46:47], v[24:25], v[78:79], v[46:47]
    v_pk_mul_f32 v[46:47], v[46:47], v[26:27]
    v_cvt_pk_bf16_f32 v107, v46, v47
    buffer_store_dwordx4 v[100:103], v28, s[16:19], s4 offen offset:0 sc1
    buffer_store_dwordx4 v[104:107], v28, s[16:19], s4 offen offset:512 sc1
    v_pk_fma_f32 v[48:49], v[24:25], v[80:81], v[48:49]
    v_pk_mul_f32 v[48:49], v[48:49], v[26:27]
    v_cvt_pk_bf16_f32 v108, v48, v49
    v_pk_fma_f32 v[50:51], v[24:25], v[82:83], v[50:51]
    v_pk_mul_f32 v[50:51], v[50:51], v[26:27]
    v_cvt_pk_bf16_f32 v109, v50, v51
    v_pk_fma_f32 v[52:53], v[24:25], v[84:85], v[52:53]
    v_pk_mul_f32 v[52:53], v[52:53], v[26:27]
    v_cvt_pk_bf16_f32 v112, v52, v53
    v_pk_fma_f32 v[54:55], v[24:25], v[86:87], v[54:55]
    v_pk_mul_f32 v[54:55], v[54:55], v[26:27]
    v_cvt_pk_bf16_f32 v113, v54, v55
    v_pk_fma_f32 v[56:57], v[24:25], v[88:89], v[56:57]
    v_pk_mul_f32 v[56:57], v[56:57], v[26:27]
    v_cvt_pk_bf16_f32 v110, v56, v57
    v_pk_fma_f32 v[58:59], v[24:25], v[90:91], v[58:59]
    v_pk_mul_f32 v[58:59], v[58:59], v[26:27]
    v_cvt_pk_bf16_f32 v111, v58, v59
    v_pk_fma_f32 v[60:61], v[24:25], v[92:93], v[60:61]
    v_pk_mul_f32 v[60:61], v[60:61], v[26:27]
    v_cvt_pk_bf16_f32 v114, v60, v61
    v_pk_fma_f32 v[62:63], v[24:25], v[94:95], v[62:63]
    v_pk_mul_f32 v[62:63], v[62:63], v[26:27]
    v_cvt_pk_bf16_f32 v115, v62, v63
    buffer_store_dwordx4 v[108:111], v28, s[16:19], s4 offen offset:1024 sc1
    buffer_store_dwordx4 v[112:115], v28, s[16:19], s4 offen offset:1536 sc1
    s_lshl_b32 s88, s34, 11
    s_lshl_b32 s4, s33, 7
    s_add_u32 s88, s88, s4
    s_add_u32 s88, s88, 139264
    s_mov_b32 s63, 1
    s_branch recurrent_scan__ssm_conv_h3__mixer_gmlp__prompt_kernel_p2
recurrent_scan__ssm_conv_h3__mixer_gmlp__prompt_kernel_aux:
    v_lshlrev_b32 v4, 7, v0
    v_cmp_gt_u32 vcc, code_end-recurrent_scan__ssm_conv_h3__mixer_gmlp__prompt_kernel, v4
    s_and_saveexec_b64 s[42:43], vcc
    s_cbranch_execz recurrent_scan__ssm_conv_h3__mixer_gmlp__prompt_kernel_cpf28
    global_load_dword v254, v4, s[40:41]
recurrent_scan__ssm_conv_h3__mixer_gmlp__prompt_kernel_cpf28:
    s_mov_b64 exec, -1
    s_sub_u32 s6, s3, 28
    s_lshl_b32 s34, s35, 2
    s_add_u32 s33, s34, s6
    s_waitcnt lgkmcnt(0)
    s_mov_b32 s28, s78
    s_mov_b32 s29, s79
    s_cmp_lg_u32 s33, 28
    s_cbranch_scc1 recurrent_scan__ssm_conv_h3__mixer_gmlp__prompt_kernel_noep9
    s_cmp_lg_u32 s30, 7
    s_cbranch_scc1 recurrent_scan__ssm_conv_h3__mixer_gmlp__prompt_kernel_noep9
    s_add_u32 s24, s28, 15499264
    s_addc_u32 s25, s29, 0
    s_mov_b32 s26, 921600
    s_mov_b32 s27, 0x00020000
    s_mov_b32 s56, s76
    s_mov_b32 s57, s77
    s_mov_b32 s58, 256
    s_mov_b32 s59, 0x00020000
    v_mov_b32 v4, 917504
    v_mov_b32 v5, 0
    s_mov_b64 exec, 1
    buffer_load_dword v6, v4, s[24:27], 0 offen sc1
    s_mov_b32 s4, 1664525
    s_waitcnt vmcnt(0)
    v_mul_lo_u32 v6, v6, s4
    v_add_u32 v6, 1013904223, v6
    v_max_u32 v6, 1, v6
    buffer_store_dword v6, v5, s[56:59], 0 offen sc1
    buffer_store_dword v6, v4, s[24:27], 0 offen sc1
    s_mov_b64 exec, -1
recurrent_scan__ssm_conv_h3__mixer_gmlp__prompt_kernel_noep9:
    s_cmp_ge_u32 s33, 28
    s_cbranch_scc1 recurrent_scan__ssm_conv_h3__mixer_gmlp__prompt_kernel_aux2
    s_mov_b32 s36, s66
    s_mov_b32 s37, s67
    s_mov_b32 s38, 1835008
    s_mov_b32 s39, 0x00020000
    s_mov_b32 s40, s68
    s_mov_b32 s41, s69
    s_mov_b32 s42, 1835008
    s_mov_b32 s43, 0x00020000
    s_mov_b32 s48, s70
    s_mov_b32 s49, s71
    s_mov_b32 s50, 3584
    s_mov_b32 s51, 0x00020000
    s_add_u32 s44, s28, 11812864
    s_addc_u32 s45, s29, 0
    s_mov_b32 s46, 1835008
    s_mov_b32 s47, 0x00020000
    s_mul_i32 s52, s33, 37
    s_lshr_b32 s52, s52, 8
    s_mul_i32 s53, s52, 7
    s_sub_u32 s53, s33, s53
    v_lshrrev_b32 v6, 3, v1
    v_mul_u32_u24 v4, 896, v6
    v_xor_b32 v5, s30, v1
    v_and_b32 v5, 7, v5
    v_lshl_add_u32 v4, v5, 4, v4
    s_lshl_b32 s54, s52, 9
    s_lshl_b32 s4, s30, 6
    s_add_u32 s54, s54, s4
    s_mul_i32 s54, s54, 896
    s_lshl_b32 s4, s53, 7
    s_add_u32 s54, s54, s4
    s_lshl_b32 s55, s30, 13
    s_sub_u32 s4, s54, 7168
    v_add_u32 v13, s4, v4
    s_lshl_b32 s5, s30, 10
    s_add_u32 m0, s5, 131072
    s_lshl_b32 s4, s53, 6
    s_lshl_b32 s5, s30, 3
    s_add_u32 s4, s4, s5
    v_add_u32 v8, s4, v6
    v_lshlrev_b32 v9, 3, v8
    buffer_load_dwordx4 v13, s[36:39], 0 offen lds
    buffer_load_dwordx2 v[150:151], v9, s[48:51], 0 offen
    s_add_u32 m0, s55, 0
    s_add_u32 s4, s54, 0
    buffer_load_dwordx4 v4, s[36:39], s4 offen nt lds
    s_add_u32 m0, s55, 65536
    s_nop 0
    buffer_load_dwordx4 v4, s[40:43], s4 offen nt lds
    s_add_u32 m0, s55, 1024
    s_add_u32 s4, s54, 7168
    buffer_load_dwordx4 v4, s[36:39], s4 offen nt lds
    s_add_u32 m0, s55, 66560
    s_nop 0
    buffer_load_dwordx4 v4, s[40:43], s4 offen nt lds
    s_barrier
    s_add_u32 m0, s55, 2048
    s_add_u32 s4, s54, 14336
    buffer_load_dwordx4 v4, s[36:39], s4 offen nt lds
    s_add_u32 m0, s55, 67584
    s_nop 0
    buffer_load_dwordx4 v4, s[40:43], s4 offen nt lds
    s_add_u32 m0, s55, 3072
    s_add_u32 s4, s54, 21504
    buffer_load_dwordx4 v4, s[36:39], s4 offen nt lds
    s_add_u32 m0, s55, 68608
    s_nop 0
    buffer_load_dwordx4 v4, s[40:43], s4 offen nt lds
    v_and_b32 v7, 7, v1
    v_lshlrev_b32 v9, 12, v8
    v_lshl_add_u32 v9, v7, 4, v9
    s_lshl_b32 s52, s52, 7
    v_xor_b32 v10, s30, v7
    v_lshlrev_b32 v10, 4, v10
    v_lshl_add_u32 v10, v6, 1, v10
    v_lshl_add_u32 v11, v7, 10, v10
    v_add_u32 v11, 131072, v11
    v_lshl_add_u32 v10, v7, 13, v10
    v_add_u32 v12, 65536, v10
    s_mov_b32 s60, 0xffff0000
    v_mov_b32 v16, 0
    v_mov_b32 v17, 0
    v_mov_b32 v18, 0
    v_mov_b32 v19, 0
    v_mov_b32 v20, 0
    v_mov_b32 v21, 0
    v_mov_b32 v22, 0
    v_mov_b32 v23, 0
    v_mov_b32 v24, 0
    v_mov_b32 v25, 0
    v_mov_b32 v26, 0
    v_mov_b32 v27, 0
    v_mov_b32 v28, 0
    v_mov_b32 v29, 0
    v_mov_b32 v30, 0
    v_mov_b32 v31, 0
    v_mov_b32 v32, 0
    v_mov_b32 v33, 0
    v_mov_b32 v34, 0
    v_mov_b32 v35, 0
    v_mov_b32 v36, 0
    v_mov_b32 v37, 0
    v_mov_b32 v38, 0
    v_mov_b32 v39, 0
    v_mov_b32 v40, 0
    v_mov_b32 v41, 0
    v_mov_b32 v42, 0
    v_mov_b32 v43, 0
    v_mov_b32 v44, 0
    v_mov_b32 v45, 0
    v_mov_b32 v46, 0
    v_mov_b32 v47, 0
    v_mov_b32 v48, 0
    v_mov_b32 v49, 0
    v_mov_b32 v50, 0
    v_mov_b32 v51, 0
    v_mov_b32 v52, 0
    v_mov_b32 v53, 0
    v_mov_b32 v54, 0
    v_mov_b32 v55, 0
    v_mov_b32 v56, 0
    v_mov_b32 v57, 0
    v_mov_b32 v58, 0
    v_mov_b32 v59, 0
    v_mov_b32 v60, 0
    v_mov_b32 v61, 0
    v_mov_b32 v62, 0
    v_mov_b32 v63, 0
    v_mov_b32 v64, 0
    v_mov_b32 v65, 0
    v_mov_b32 v66, 0
    v_mov_b32 v67, 0
    v_mov_b32 v68, 0
    v_mov_b32 v69, 0
    v_mov_b32 v70, 0
    v_mov_b32 v71, 0
    v_mov_b32 v72, 0
    v_mov_b32 v73, 0
    v_mov_b32 v74, 0
    v_mov_b32 v75, 0
    v_mov_b32 v76, 0
    v_mov_b32 v77, 0
    v_mov_b32 v78, 0
    v_mov_b32 v79, 0
    v_mov_b32 v80, 0
    v_mov_b32 v81, 0
    v_mov_b32 v82, 0
    v_mov_b32 v83, 0
    v_mov_b32 v84, 0
    v_mov_b32 v85, 0
    v_mov_b32 v86, 0
    v_mov_b32 v87, 0
    v_mov_b32 v88, 0
    v_mov_b32 v89, 0
    v_mov_b32 v90, 0
    v_mov_b32 v91, 0
    v_mov_b32 v92, 0
    v_mov_b32 v93, 0
    v_mov_b32 v94, 0
    v_mov_b32 v95, 0
    v_mov_b32 v96, 0
    v_mov_b32 v97, 0
    v_mov_b32 v98, 0
    v_mov_b32 v99, 0
    v_mov_b32 v100, 0
    v_mov_b32 v101, 0
    v_mov_b32 v102, 0
    v_mov_b32 v103, 0
    v_mov_b32 v104, 0
    v_mov_b32 v105, 0
    v_mov_b32 v106, 0
    v_mov_b32 v107, 0
    v_mov_b32 v108, 0
    v_mov_b32 v109, 0
    v_mov_b32 v110, 0
    v_mov_b32 v111, 0
    v_mov_b32 v112, 0
    v_mov_b32 v113, 0
    v_mov_b32 v114, 0
    v_mov_b32 v115, 0
    v_mov_b32 v116, 0
    v_mov_b32 v117, 0
    v_mov_b32 v118, 0
    v_mov_b32 v119, 0
    v_mov_b32 v120, 0
    v_mov_b32 v121, 0
    v_mov_b32 v122, 0
    v_mov_b32 v123, 0
    v_mov_b32 v124, 0
    v_mov_b32 v125, 0
    v_mov_b32 v126, 0
    v_mov_b32 v127, 0
    v_mov_b32 v128, 0
    v_mov_b32 v129, 0
    v_mov_b32 v130, 0
    v_mov_b32 v131, 0
    v_mov_b32 v132, 0
    v_mov_b32 v133, 0
    v_mov_b32 v134, 0
    v_mov_b32 v135, 0
    v_mov_b32 v136, 0
    v_mov_b32 v137, 0
    v_mov_b32 v138, 0
    v_mov_b32 v139, 0
    v_mov_b32 v140, 0
    v_mov_b32 v141, 0
    v_mov_b32 v142, 0
    v_mov_b32 v143, 0
    v_mov_b32 v144, 0
    v_mov_b32 v145, 0
    v_mov_b32 v146, 0
    v_mov_b32 v147, 0
    s_waitcnt vmcnt(4)
    s_barrier
    ds_read_u16_d16_hi v16, v11 offset:640
    ds_read_u16_d16_hi v17, v11 offset:768
    ds_read_u16_d16_hi v18, v11 offset:896
    v_lshlrev_b32 v152, 16, v150
    v_and_b32 v153, s60, v150
    v_lshlrev_b32 v154, 16, v151
    v_and_b32 v155, s60, v151
    ds_read_u16_d16_hi v19, v10 offset:0
    ds_read_u16_d16_hi v20, v10 offset:128
    ds_read_u16_d16_hi v21, v10 offset:256
    ds_read_u16_d16_hi v22, v10 offset:384
    ds_read_u16_d16_hi v23, v10 offset:512
    ds_read_u16_d16_hi v24, v10 offset:640
    ds_read_u16_d16_hi v25, v10 offset:768
    ds_read_u16_d16_hi v26, v10 offset:896
    ds_read_u16_d16_hi v84, v12 offset:0
    ds_read_u16_d16_hi v85, v12 offset:128
    ds_read_u16_d16_hi v86, v12 offset:256
    ds_read_u16_d16_hi v87, v12 offset:384
    ds_read_u16_d16_hi v88, v12 offset:512
    ds_read_u16_d16_hi v89, v12 offset:640
    ds_read_u16_d16_hi v90, v12 offset:768
    ds_read_u16_d16_hi v91, v12 offset:896
    s_add_u32 m0, s55, 4096
    s_add_u32 s4, s54, 28672
    buffer_load_dwordx4 v4, s[36:39], s4 offen nt lds
    s_add_u32 m0, s55, 69632
    s_nop 0
    buffer_load_dwordx4 v4, s[40:43], s4 offen nt lds
    s_add_u32 m0, s55, 5120
    s_add_u32 s4, s54, 35840
    buffer_load_dwordx4 v4, s[36:39], s4 offen nt lds
    s_add_u32 m0, s55, 70656
    s_nop 0
    buffer_load_dwordx4 v4, s[40:43], s4 offen nt lds
    s_waitcnt lgkmcnt(0)
    ds_read_u16_d16_hi v27, v10 offset:1024
    ds_read_u16_d16_hi v28, v10 offset:1152
    ds_read_u16_d16_hi v29, v10 offset:1280
    ds_read_u16_d16_hi v30, v10 offset:1408
    ds_read_u16_d16_hi v31, v10 offset:1536
    ds_read_u16_d16_hi v32, v10 offset:1664
    ds_read_u16_d16_hi v33, v10 offset:1792
    ds_read_u16_d16_hi v34, v10 offset:1920
    ds_read_u16_d16_hi v92, v12 offset:1024
    ds_read_u16_d16_hi v93, v12 offset:1152
    ds_read_u16_d16_hi v94, v12 offset:1280
    ds_read_u16_d16_hi v95, v12 offset:1408
    ds_read_u16_d16_hi v96, v12 offset:1536
    ds_read_u16_d16_hi v97, v12 offset:1664
    ds_read_u16_d16_hi v98, v12 offset:1792
    ds_read_u16_d16_hi v99, v12 offset:1920
    v_mul_f32 v160, v16, v155
    v_fmac_f32 v160, v17, v154
    v_fmac_f32 v160, v18, v153
    v_fmac_f32 v160, v19, v152
    v_mul_f32 v160, v160, v84
    v_mul_f32 v161, v17, v155
    v_fmac_f32 v161, v18, v154
    v_fmac_f32 v161, v19, v153
    v_fmac_f32 v161, v20, v152
    v_mul_f32 v161, v161, v85
    v_mul_f32 v162, v18, v155
    v_fmac_f32 v162, v19, v154
    v_fmac_f32 v162, v20, v153
    v_fmac_f32 v162, v21, v152
    v_mul_f32 v162, v162, v86
    v_mul_f32 v163, v19, v155
    v_fmac_f32 v163, v20, v154
    v_fmac_f32 v163, v21, v153
    v_fmac_f32 v163, v22, v152
    v_mul_f32 v163, v163, v87
    v_mul_f32 v164, v20, v155
    v_fmac_f32 v164, v21, v154
    v_fmac_f32 v164, v22, v153
    v_fmac_f32 v164, v23, v152
    v_mul_f32 v164, v164, v88
    v_mul_f32 v165, v21, v155
    v_fmac_f32 v165, v22, v154
    v_fmac_f32 v165, v23, v153
    v_fmac_f32 v165, v24, v152
    v_mul_f32 v165, v165, v89
    v_mul_f32 v166, v22, v155
    v_fmac_f32 v166, v23, v154
    v_fmac_f32 v166, v24, v153
    v_fmac_f32 v166, v25, v152
    v_mul_f32 v166, v166, v90
    v_mul_f32 v167, v23, v155
    v_fmac_f32 v167, v24, v154
    v_fmac_f32 v167, v25, v153
    v_fmac_f32 v167, v26, v152
    v_mul_f32 v167, v167, v91
    v_cvt_pk_bf16_f32 v168, v160, v161
    v_cvt_pk_bf16_f32 v169, v162, v163
    v_cvt_pk_bf16_f32 v170, v164, v165
    v_cvt_pk_bf16_f32 v171, v166, v167
    buffer_store_dwordx4 v[168:171], v9, s[44:47], s52 offen offset:0 sc1
    s_waitcnt lgkmcnt(0)
    v_mul_f32 v160, v24, v155
    v_fmac_f32 v160, v25, v154
    v_fmac_f32 v160, v26, v153
    v_fmac_f32 v160, v27, v152
    v_mul_f32 v160, v160, v92
    v_mul_f32 v161, v25, v155
    v_fmac_f32 v161, v26, v154
    v_fmac_f32 v161, v27, v153
    v_fmac_f32 v161, v28, v152
    v_mul_f32 v161, v161, v93
    v_mul_f32 v162, v26, v155
    v_fmac_f32 v162, v27, v154
    v_fmac_f32 v162, v28, v153
    v_fmac_f32 v162, v29, v152
    v_mul_f32 v162, v162, v94
    v_mul_f32 v163, v27, v155
    v_fmac_f32 v163, v28, v154
    v_fmac_f32 v163, v29, v153
    v_fmac_f32 v163, v30, v152
    v_mul_f32 v163, v163, v95
    v_mul_f32 v164, v28, v155
    v_fmac_f32 v164, v29, v154
    v_fmac_f32 v164, v30, v153
    v_fmac_f32 v164, v31, v152
    v_mul_f32 v164, v164, v96
    v_mul_f32 v165, v29, v155
    v_fmac_f32 v165, v30, v154
    v_fmac_f32 v165, v31, v153
    v_fmac_f32 v165, v32, v152
    v_mul_f32 v165, v165, v97
    v_mul_f32 v166, v30, v155
    v_fmac_f32 v166, v31, v154
    v_fmac_f32 v166, v32, v153
    v_fmac_f32 v166, v33, v152
    v_mul_f32 v166, v166, v98
    v_mul_f32 v167, v31, v155
    v_fmac_f32 v167, v32, v154
    v_fmac_f32 v167, v33, v153
    v_fmac_f32 v167, v34, v152
    v_mul_f32 v167, v167, v99
    v_cvt_pk_bf16_f32 v172, v160, v161
    v_cvt_pk_bf16_f32 v173, v162, v163
    v_cvt_pk_bf16_f32 v174, v164, v165
    v_cvt_pk_bf16_f32 v175, v166, v167
    buffer_store_dwordx4 v[172:175], v9, s[44:47], s52 offen offset:512 sc1
    s_waitcnt vmcnt(6)
    s_barrier
    ds_read_u16_d16_hi v35, v10 offset:2048
    ds_read_u16_d16_hi v36, v10 offset:2176
    ds_read_u16_d16_hi v37, v10 offset:2304
    ds_read_u16_d16_hi v38, v10 offset:2432
    ds_read_u16_d16_hi v39, v10 offset:2560
    ds_read_u16_d16_hi v40, v10 offset:2688
    ds_read_u16_d16_hi v41, v10 offset:2816
    ds_read_u16_d16_hi v42, v10 offset:2944
    ds_read_u16_d16_hi v100, v12 offset:2048
    ds_read_u16_d16_hi v101, v12 offset:2176
    ds_read_u16_d16_hi v102, v12 offset:2304
    ds_read_u16_d16_hi v103, v12 offset:2432
    ds_read_u16_d16_hi v104, v12 offset:2560
    ds_read_u16_d16_hi v105, v12 offset:2688
    ds_read_u16_d16_hi v106, v12 offset:2816
    ds_read_u16_d16_hi v107, v12 offset:2944
    s_add_u32 m0, s55, 6144
    s_add_u32 s4, s54, 43008
    buffer_load_dwordx4 v4, s[36:39], s4 offen nt lds
    s_add_u32 m0, s55, 71680
    s_nop 0
    buffer_load_dwordx4 v4, s[40:43], s4 offen nt lds
    s_add_u32 m0, s55, 7168
    s_add_u32 s4, s54, 50176
    buffer_load_dwordx4 v4, s[36:39], s4 offen nt lds
    s_add_u32 m0, s55, 72704
    s_nop 0
    buffer_load_dwordx4 v4, s[40:43], s4 offen nt lds
    s_waitcnt lgkmcnt(0)
    ds_read_u16_d16_hi v43, v10 offset:3072
    ds_read_u16_d16_hi v44, v10 offset:3200
    ds_read_u16_d16_hi v45, v10 offset:3328
    ds_read_u16_d16_hi v46, v10 offset:3456
    ds_read_u16_d16_hi v47, v10 offset:3584
    ds_read_u16_d16_hi v48, v10 offset:3712
    ds_read_u16_d16_hi v49, v10 offset:3840
    ds_read_u16_d16_hi v50, v10 offset:3968
    ds_read_u16_d16_hi v108, v12 offset:3072
    ds_read_u16_d16_hi v109, v12 offset:3200
    ds_read_u16_d16_hi v110, v12 offset:3328
    ds_read_u16_d16_hi v111, v12 offset:3456
    ds_read_u16_d16_hi v112, v12 offset:3584
    ds_read_u16_d16_hi v113, v12 offset:3712
    ds_read_u16_d16_hi v114, v12 offset:3840
    ds_read_u16_d16_hi v115, v12 offset:3968
    v_mul_f32 v160, v32, v155
    v_fmac_f32 v160, v33, v154
    v_fmac_f32 v160, v34, v153
    v_fmac_f32 v160, v35, v152
    v_mul_f32 v160, v160, v100
    v_mul_f32 v161, v33, v155
    v_fmac_f32 v161, v34, v154
    v_fmac_f32 v161, v35, v153
    v_fmac_f32 v161, v36, v152
    v_mul_f32 v161, v161, v101
    v_mul_f32 v162, v34, v155
    v_fmac_f32 v162, v35, v154
    v_fmac_f32 v162, v36, v153
    v_fmac_f32 v162, v37, v152
    v_mul_f32 v162, v162, v102
    v_mul_f32 v163, v35, v155
    v_fmac_f32 v163, v36, v154
    v_fmac_f32 v163, v37, v153
    v_fmac_f32 v163, v38, v152
    v_mul_f32 v163, v163, v103
    v_mul_f32 v164, v36, v155
    v_fmac_f32 v164, v37, v154
    v_fmac_f32 v164, v38, v153
    v_fmac_f32 v164, v39, v152
    v_mul_f32 v164, v164, v104
    v_mul_f32 v165, v37, v155
    v_fmac_f32 v165, v38, v154
    v_fmac_f32 v165, v39, v153
    v_fmac_f32 v165, v40, v152
    v_mul_f32 v165, v165, v105
    v_mul_f32 v166, v38, v155
    v_fmac_f32 v166, v39, v154
    v_fmac_f32 v166, v40, v153
    v_fmac_f32 v166, v41, v152
    v_mul_f32 v166, v166, v106
    v_mul_f32 v167, v39, v155
    v_fmac_f32 v167, v40, v154
    v_fmac_f32 v167, v41, v153
    v_fmac_f32 v167, v42, v152
    v_mul_f32 v167, v167, v107
    v_cvt_pk_bf16_f32 v168, v160, v161
    v_cvt_pk_bf16_f32 v169, v162, v163
    v_cvt_pk_bf16_f32 v170, v164, v165
    v_cvt_pk_bf16_f32 v171, v166, v167
    buffer_store_dwordx4 v[168:171], v9, s[44:47], s52 offen offset:1024 sc1
    s_waitcnt lgkmcnt(0)
    v_mul_f32 v160, v40, v155
    v_fmac_f32 v160, v41, v154
    v_fmac_f32 v160, v42, v153
    v_fmac_f32 v160, v43, v152
    v_mul_f32 v160, v160, v108
    v_mul_f32 v161, v41, v155
    v_fmac_f32 v161, v42, v154
    v_fmac_f32 v161, v43, v153
    v_fmac_f32 v161, v44, v152
    v_mul_f32 v161, v161, v109
    v_mul_f32 v162, v42, v155
    v_fmac_f32 v162, v43, v154
    v_fmac_f32 v162, v44, v153
    v_fmac_f32 v162, v45, v152
    v_mul_f32 v162, v162, v110
    v_mul_f32 v163, v43, v155
    v_fmac_f32 v163, v44, v154
    v_fmac_f32 v163, v45, v153
    v_fmac_f32 v163, v46, v152
    v_mul_f32 v163, v163, v111
    v_mul_f32 v164, v44, v155
    v_fmac_f32 v164, v45, v154
    v_fmac_f32 v164, v46, v153
    v_fmac_f32 v164, v47, v152
    v_mul_f32 v164, v164, v112
    v_mul_f32 v165, v45, v155
    v_fmac_f32 v165, v46, v154
    v_fmac_f32 v165, v47, v153
    v_fmac_f32 v165, v48, v152
    v_mul_f32 v165, v165, v113
    v_mul_f32 v166, v46, v155
    v_fmac_f32 v166, v47, v154
    v_fmac_f32 v166, v48, v153
    v_fmac_f32 v166, v49, v152
    v_mul_f32 v166, v166, v114
    v_mul_f32 v167, v47, v155
    v_fmac_f32 v167, v48, v154
    v_fmac_f32 v167, v49, v153
    v_fmac_f32 v167, v50, v152
    v_mul_f32 v167, v167, v115
    v_cvt_pk_bf16_f32 v172, v160, v161
    v_cvt_pk_bf16_f32 v173, v162, v163
    v_cvt_pk_bf16_f32 v174, v164, v165
    v_cvt_pk_bf16_f32 v175, v166, v167
    buffer_store_dwordx4 v[172:175], v9, s[44:47], s52 offen offset:1536 sc1
    s_waitcnt vmcnt(8)
    s_barrier
    ds_read_u16_d16_hi v51, v10 offset:4096
    ds_read_u16_d16_hi v52, v10 offset:4224
    ds_read_u16_d16_hi v53, v10 offset:4352
    ds_read_u16_d16_hi v54, v10 offset:4480
    ds_read_u16_d16_hi v55, v10 offset:4608
    ds_read_u16_d16_hi v56, v10 offset:4736
    ds_read_u16_d16_hi v57, v10 offset:4864
    ds_read_u16_d16_hi v58, v10 offset:4992
    ds_read_u16_d16_hi v116, v12 offset:4096
    ds_read_u16_d16_hi v117, v12 offset:4224
    ds_read_u16_d16_hi v118, v12 offset:4352
    ds_read_u16_d16_hi v119, v12 offset:4480
    ds_read_u16_d16_hi v120, v12 offset:4608
    ds_read_u16_d16_hi v121, v12 offset:4736
    ds_read_u16_d16_hi v122, v12 offset:4864
    ds_read_u16_d16_hi v123, v12 offset:4992
    s_waitcnt lgkmcnt(0)
    ds_read_u16_d16_hi v59, v10 offset:5120
    ds_read_u16_d16_hi v60, v10 offset:5248
    ds_read_u16_d16_hi v61, v10 offset:5376
    ds_read_u16_d16_hi v62, v10 offset:5504
    ds_read_u16_d16_hi v63, v10 offset:5632
    ds_read_u16_d16_hi v64, v10 offset:5760
    ds_read_u16_d16_hi v65, v10 offset:5888
    ds_read_u16_d16_hi v66, v10 offset:6016
    ds_read_u16_d16_hi v124, v12 offset:5120
    ds_read_u16_d16_hi v125, v12 offset:5248
    ds_read_u16_d16_hi v126, v12 offset:5376
    ds_read_u16_d16_hi v127, v12 offset:5504
    ds_read_u16_d16_hi v128, v12 offset:5632
    ds_read_u16_d16_hi v129, v12 offset:5760
    ds_read_u16_d16_hi v130, v12 offset:5888
    ds_read_u16_d16_hi v131, v12 offset:6016
    v_mul_f32 v160, v48, v155
    v_fmac_f32 v160, v49, v154
    v_fmac_f32 v160, v50, v153
    v_fmac_f32 v160, v51, v152
    v_mul_f32 v160, v160, v116
    v_mul_f32 v161, v49, v155
    v_fmac_f32 v161, v50, v154
    v_fmac_f32 v161, v51, v153
    v_fmac_f32 v161, v52, v152
    v_mul_f32 v161, v161, v117
    v_mul_f32 v162, v50, v155
    v_fmac_f32 v162, v51, v154
    v_fmac_f32 v162, v52, v153
    v_fmac_f32 v162, v53, v152
    v_mul_f32 v162, v162, v118
    v_mul_f32 v163, v51, v155
    v_fmac_f32 v163, v52, v154
    v_fmac_f32 v163, v53, v153
    v_fmac_f32 v163, v54, v152
    v_mul_f32 v163, v163, v119
    v_mul_f32 v164, v52, v155
    v_fmac_f32 v164, v53, v154
    v_fmac_f32 v164, v54, v153
    v_fmac_f32 v164, v55, v152
    v_mul_f32 v164, v164, v120
    v_mul_f32 v165, v53, v155
    v_fmac_f32 v165, v54, v154
    v_fmac_f32 v165, v55, v153
    v_fmac_f32 v165, v56, v152
    v_mul_f32 v165, v165, v121
    v_mul_f32 v166, v54, v155
    v_fmac_f32 v166, v55, v154
    v_fmac_f32 v166, v56, v153
    v_fmac_f32 v166, v57, v152
    v_mul_f32 v166, v166, v122
    v_mul_f32 v167, v55, v155
    v_fmac_f32 v167, v56, v154
    v_fmac_f32 v167, v57, v153
    v_fmac_f32 v167, v58, v152
    v_mul_f32 v167, v167, v123
    v_cvt_pk_bf16_f32 v168, v160, v161
    v_cvt_pk_bf16_f32 v169, v162, v163
    v_cvt_pk_bf16_f32 v170, v164, v165
    v_cvt_pk_bf16_f32 v171, v166, v167
    buffer_store_dwordx4 v[168:171], v9, s[44:47], s52 offen offset:2048 sc1
    s_waitcnt lgkmcnt(0)
    v_mul_f32 v160, v56, v155
    v_fmac_f32 v160, v57, v154
    v_fmac_f32 v160, v58, v153
    v_fmac_f32 v160, v59, v152
    v_mul_f32 v160, v160, v124
    v_mul_f32 v161, v57, v155
    v_fmac_f32 v161, v58, v154
    v_fmac_f32 v161, v59, v153
    v_fmac_f32 v161, v60, v152
    v_mul_f32 v161, v161, v125
    v_mul_f32 v162, v58, v155
    v_fmac_f32 v162, v59, v154
    v_fmac_f32 v162, v60, v153
    v_fmac_f32 v162, v61, v152
    v_mul_f32 v162, v162, v126
    v_mul_f32 v163, v59, v155
    v_fmac_f32 v163, v60, v154
    v_fmac_f32 v163, v61, v153
    v_fmac_f32 v163, v62, v152
    v_mul_f32 v163, v163, v127
    v_mul_f32 v164, v60, v155
    v_fmac_f32 v164, v61, v154
    v_fmac_f32 v164, v62, v153
    v_fmac_f32 v164, v63, v152
    v_mul_f32 v164, v164, v128
    v_mul_f32 v165, v61, v155
    v_fmac_f32 v165, v62, v154
    v_fmac_f32 v165, v63, v153
    v_fmac_f32 v165, v64, v152
    v_mul_f32 v165, v165, v129
    v_mul_f32 v166, v62, v155
    v_fmac_f32 v166, v63, v154
    v_fmac_f32 v166, v64, v153
    v_fmac_f32 v166, v65, v152
    v_mul_f32 v166, v166, v130
    v_mul_f32 v167, v63, v155
    v_fmac_f32 v167, v64, v154
    v_fmac_f32 v167, v65, v153
    v_fmac_f32 v167, v66, v152
    v_mul_f32 v167, v167, v131
    v_cvt_pk_bf16_f32 v172, v160, v161
    v_cvt_pk_bf16_f32 v173, v162, v163
    v_cvt_pk_bf16_f32 v174, v164, v165
    v_cvt_pk_bf16_f32 v175, v166, v167
    buffer_store_dwordx4 v[172:175], v9, s[44:47], s52 offen offset:2560 sc1
    s_waitcnt vmcnt(4)
    s_barrier
    ds_read_u16_d16_hi v67, v10 offset:6144
    ds_read_u16_d16_hi v68, v10 offset:6272
    ds_read_u16_d16_hi v69, v10 offset:6400
    ds_read_u16_d16_hi v70, v10 offset:6528
    ds_read_u16_d16_hi v71, v10 offset:6656
    ds_read_u16_d16_hi v72, v10 offset:6784
    ds_read_u16_d16_hi v73, v10 offset:6912
    ds_read_u16_d16_hi v74, v10 offset:7040
    ds_read_u16_d16_hi v132, v12 offset:6144
    ds_read_u16_d16_hi v133, v12 offset:6272
    ds_read_u16_d16_hi v134, v12 offset:6400
    ds_read_u16_d16_hi v135, v12 offset:6528
    ds_read_u16_d16_hi v136, v12 offset:6656
    ds_read_u16_d16_hi v137, v12 offset:6784
    ds_read_u16_d16_hi v138, v12 offset:6912
    ds_read_u16_d16_hi v139, v12 offset:7040
    s_waitcnt lgkmcnt(0)
    ds_read_u16_d16_hi v75, v10 offset:7168
    ds_read_u16_d16_hi v76, v10 offset:7296
    ds_read_u16_d16_hi v77, v10 offset:7424
    ds_read_u16_d16_hi v78, v10 offset:7552
    ds_read_u16_d16_hi v79, v10 offset:7680
    ds_read_u16_d16_hi v80, v10 offset:7808
    ds_read_u16_d16_hi v81, v10 offset:7936
    ds_read_u16_d16_hi v82, v10 offset:8064
    ds_read_u16_d16_hi v140, v12 offset:7168
    ds_read_u16_d16_hi v141, v12 offset:7296
    ds_read_u16_d16_hi v142, v12 offset:7424
    ds_read_u16_d16_hi v143, v12 offset:7552
    ds_read_u16_d16_hi v144, v12 offset:7680
    ds_read_u16_d16_hi v145, v12 offset:7808
    ds_read_u16_d16_hi v146, v12 offset:7936
    ds_read_u16_d16_hi v147, v12 offset:8064
    v_mul_f32 v160, v64, v155
    v_fmac_f32 v160, v65, v154
    v_fmac_f32 v160, v66, v153
    v_fmac_f32 v160, v67, v152
    v_mul_f32 v160, v160, v132
    v_mul_f32 v161, v65, v155
    v_fmac_f32 v161, v66, v154
    v_fmac_f32 v161, v67, v153
    v_fmac_f32 v161, v68, v152
    v_mul_f32 v161, v161, v133
    v_mul_f32 v162, v66, v155
    v_fmac_f32 v162, v67, v154
    v_fmac_f32 v162, v68, v153
    v_fmac_f32 v162, v69, v152
    v_mul_f32 v162, v162, v134
    v_mul_f32 v163, v67, v155
    v_fmac_f32 v163, v68, v154
    v_fmac_f32 v163, v69, v153
    v_fmac_f32 v163, v70, v152
    v_mul_f32 v163, v163, v135
    v_mul_f32 v164, v68, v155
    v_fmac_f32 v164, v69, v154
    v_fmac_f32 v164, v70, v153
    v_fmac_f32 v164, v71, v152
    v_mul_f32 v164, v164, v136
    v_mul_f32 v165, v69, v155
    v_fmac_f32 v165, v70, v154
    v_fmac_f32 v165, v71, v153
    v_fmac_f32 v165, v72, v152
    v_mul_f32 v165, v165, v137
    v_mul_f32 v166, v70, v155
    v_fmac_f32 v166, v71, v154
    v_fmac_f32 v166, v72, v153
    v_fmac_f32 v166, v73, v152
    v_mul_f32 v166, v166, v138
    v_mul_f32 v167, v71, v155
    v_fmac_f32 v167, v72, v154
    v_fmac_f32 v167, v73, v153
    v_fmac_f32 v167, v74, v152
    v_mul_f32 v167, v167, v139
    v_cvt_pk_bf16_f32 v168, v160, v161
    v_cvt_pk_bf16_f32 v169, v162, v163
    v_cvt_pk_bf16_f32 v170, v164, v165
    v_cvt_pk_bf16_f32 v171, v166, v167
    buffer_store_dwordx4 v[168:171], v9, s[44:47], s52 offen offset:3072 sc1
    s_waitcnt lgkmcnt(0)
    v_mul_f32 v160, v72, v155
    v_fmac_f32 v160, v73, v154
    v_fmac_f32 v160, v74, v153
    v_fmac_f32 v160, v75, v152
    v_mul_f32 v160, v160, v140
    v_mul_f32 v161, v73, v155
    v_fmac_f32 v161, v74, v154
    v_fmac_f32 v161, v75, v153
    v_fmac_f32 v161, v76, v152
    v_mul_f32 v161, v161, v141
    v_mul_f32 v162, v74, v155
    v_fmac_f32 v162, v75, v154
    v_fmac_f32 v162, v76, v153
    v_fmac_f32 v162, v77, v152
    v_mul_f32 v162, v162, v142
    v_mul_f32 v163, v75, v155
    v_fmac_f32 v163, v76, v154
    v_fmac_f32 v163, v77, v153
    v_fmac_f32 v163, v78, v152
    v_mul_f32 v163, v163, v143
    v_mul_f32 v164, v76, v155
    v_fmac_f32 v164, v77, v154
    v_fmac_f32 v164, v78, v153
    v_fmac_f32 v164, v79, v152
    v_mul_f32 v164, v164, v144
    v_mul_f32 v165, v77, v155
    v_fmac_f32 v165, v78, v154
    v_fmac_f32 v165, v79, v153
    v_fmac_f32 v165, v80, v152
    v_mul_f32 v165, v165, v145
    v_mul_f32 v166, v78, v155
    v_fmac_f32 v166, v79, v154
    v_fmac_f32 v166, v80, v153
    v_fmac_f32 v166, v81, v152
    v_mul_f32 v166, v166, v146
    v_mul_f32 v167, v79, v155
    v_fmac_f32 v167, v80, v154
    v_fmac_f32 v167, v81, v153
    v_fmac_f32 v167, v82, v152
    v_mul_f32 v167, v167, v147
    v_cvt_pk_bf16_f32 v172, v160, v161
    v_cvt_pk_bf16_f32 v173, v162, v163
    v_cvt_pk_bf16_f32 v174, v164, v165
    v_cvt_pk_bf16_f32 v175, v166, v167
    buffer_store_dwordx4 v[172:175], v9, s[44:47], s52 offen offset:3584 sc1
    s_lshl_b32 s88, s53, 9
    s_add_u32 s88, s88, s52
    s_add_u32 s88, s88, 172032
    s_barrier
    s_branch recurrent_scan__ssm_conv_h3__mixer_gmlp__prompt_kernel_aux3
recurrent_scan__ssm_conv_h3__mixer_gmlp__prompt_kernel_aux2:
    s_lshl_b32 s88, s33, 7
    s_add_u32 s88, s88, 172032
    s_barrier
    s_mov_b32 s16, s74
    s_mov_b32 s17, s75
    s_mov_b32 s18, 8388608
    s_mov_b32 s19, 0x00020000
    s_and_b32 s4, s30, 3
    s_lshl_b32 s4, s4, 21
    s_lshr_b32 s5, s30, 2
    s_lshl_b32 s5, s5, 20
    s_add_u32 s4, s4, s5
    s_lshl_b32 s5, s3, 15
    s_add_u32 s4, s4, s5
    v_lshlrev_b32 v30, 7, v1
    s_add_u32 s5, s4, 0
    buffer_load_dword v32, v30, s[16:19], s5 offen
    s_add_u32 s5, s4, 8192
    buffer_load_dword v33, v30, s[16:19], s5 offen
    s_add_u32 s5, s4, 16384
    buffer_load_dword v34, v30, s[16:19], s5 offen
    s_add_u32 s5, s4, 24576
    buffer_load_dword v35, v30, s[16:19], s5 offen
recurrent_scan__ssm_conv_h3__mixer_gmlp__prompt_kernel_aux3:
    s_mov_b32 s63, 0
recurrent_scan__ssm_conv_h3__mixer_gmlp__prompt_kernel_p2:
    s_mov_b32 s52, s76
    s_mov_b32 s53, s77
    s_mov_b32 s54, 256
    s_mov_b32 s55, 0x00020000
    s_cmp_ge_u32 s30, 4
    s_cbranch_scc1 recurrent_scan__ssm_conv_h3__mixer_gmlp__prompt_kernel_hlp
    s_load_dwordx4 s[4:7], s[0:1], 64
    s_load_dwordx2 s[84:85], s[0:1], 0
    s_load_dwordx2 s[86:87], s[0:1], 88
    v_mov_b32 v17, 0
    buffer_load_dword v16, v17, s[52:55], 0 offen sc1
    s_waitcnt lgkmcnt(0)
    s_mov_b32 s8, s4
    s_mov_b32 s9, s5
    s_mov_b32 s10, 8388608
    s_mov_b32 s11, 0x00020000
    s_mov_b32 s12, s28
    s_mov_b32 s13, s29
    s_mov_b32 s14, 3670016
    s_mov_b32 s15, 0x00020000
    s_add_u32 s16, s28, 3670016
    s_addc_u32 s17, s29, 0
    s_mov_b32 s18, 3670016
    s_mov_b32 s19, 0x00020000
    s_add_u32 s20, s28, 7340032
    s_addc_u32 s21, s29, 0
    s_mov_b32 s22, 3670016
    s_mov_b32 s23, 0x00020000
    s_mov_b32 s24, s6
    s_mov_b32 s25, s7
    s_mov_b32 s26, 4096
    s_mov_b32 s27, 0x00020000
    s_and_b32 s31, s2, 7
    s_lshr_b32 s32, s2, 3
    s_and_b32 s33, s31, 3
    s_lshl_b32 s33, s33, 3
    s_and_b32 s34, s32, 7
    s_add_u32 s33, s33, s34
    s_lshr_b32 s34, s31, 2
    s_lshl_b32 s34, s34, 2
    s_lshr_b32 s35, s32, 3
    s_add_u32 s34, s34, s35
    v_and_b32 v1, 63, v0
    v_and_b32 v2, 15, v0
    v_lshrrev_b32 v3, 4, v1
    v_lshlrev_b32 v4, 4, v1
    v_add_u32 v5, 0x1000, v4
    v_xor_b32 v10, v3, v1
    v_and_b32 v10, 7, v10
    v_lshrrev_b32 v11, 3, v1
    v_lshlrev_b32 v11, 12, v11
    v_lshl_add_u32 v6, v10, 4, v11
    v_xor_b32 v7, 64, v6
    v_add_u32 v7, 0x8000, v7
    s_lshl_b32 s35, s33, 18
    v_add_u32 v6, s35, v6
    v_add_u32 v7, s35, v7
    v_lshrrev_b32 v11, 1, v2
    v_xor_b32 v11, v11, v3
    v_lshlrev_b32 v11, 4, v11
    v_lshl_add_u32 v11, v2, 7, v11
    s_lshl_b32 s60, s30, 14
    v_add_u32 v12, s60, v11
    v_xor_b32 v13, 64, v12
    s_mov_b32 s66, s30
    s_xor_b32 s36, s30, 0
    s_lshl_b32 s36, s36, 16
    s_lshl_b32 s37, s66, 7
    s_add_u32 s62, s36, s37
    s_xor_b32 s36, s30, 1
    s_lshl_b32 s36, s36, 16
    s_lshl_b32 s37, s66, 7
    s_add_u32 s63, s36, s37
    s_xor_b32 s36, s30, 2
    s_lshl_b32 s36, s36, 16
    s_lshl_b32 s37, s66, 7
    s_add_u32 s64, s36, s37
    s_xor_b32 s36, s30, 3
    s_lshl_b32 s36, s36, 16
    s_lshl_b32 s37, s66, 7
    s_add_u32 s65, s36, s37
    s_mul_i32 s38, s66, 114688
    s_mul_i32 s39, s34, 7168
    s_add_u32 s38, s38, s39
    s_and_b32 s67, s34, 1
    s_lshl_b32 s39, s67, 10
    s_add_u32 s38, s38, s39
    s_mul_i32 s68, s67, 7168
    s_add_u32 s61, s34, s33
    s_add_u32 s44, s28, 16420864
    s_addc_u32 s45, s29, 0
    s_mov_b32 s46, 270336
    s_mov_b32 s47, 0x00020000
    v_mov_b32 v18, 163328
    s_waitcnt vmcnt(0)
    s_mov_b32 s57, 65536
recurrent_scan__ssm_conv_h3__mixer_gmlp__prompt_kernel_ep10:
    v_readfirstlane_b32 s59, v16
    s_cmp_lg_u32 s59, 0
    s_cbranch_scc1 recurrent_scan__ssm_conv_h3__mixer_gmlp__prompt_kernel_epk11
    s_sub_u32 s57, s57, 1
    s_cmp_eq_u32 s57, 0
    s_cbranch_scc1 recurrent_scan__ssm_conv_h3__mixer_gmlp__prompt_kernel_epk11
    s_sleep 2
    buffer_load_dword v16, v17, s[52:55], 0 offen sc1
    s_waitcnt vmcnt(0)
    s_branch recurrent_scan__ssm_conv_h3__mixer_gmlp__prompt_kernel_ep10
recurrent_scan__ssm_conv_h3__mixer_gmlp__prompt_kernel_epk11:
    v_mov_b32 v19, 1
    s_mov_b64 exec, 1
    ds_add_rtn_u32 v19, v18, v19 offset:4
    s_mov_b64 exec, -1
    v_lshlrev_b32 v20, 2, v1
    s_waitcnt lgkmcnt(0)
    v_readfirstlane_b32 s56, v19
    v_mov_b32 v19, s59
    s_cmp_lg_u32 s56, 3
    s_cbranch_scc1 recurrent_scan__ssm_conv_h3__mixer_gmlp__prompt_kernel_nf12
    s_mov_b32 exec_hi, 0
    buffer_store_dword v19, v20, s[44:47], s88 offen sc1
    s_mov_b64 exec, -1
recurrent_scan__ssm_conv_h3__mixer_gmlp__prompt_kernel_nf12:
    s_mov_b32 s57, 0x400000
recurrent_scan__ssm_conv_h3__mixer_gmlp__prompt_kernel_lw15:
    ds_read_b32 v20, v18 offset:4
    s_sub_u32 s57, s57, 1
    s_waitcnt lgkmcnt(0)
    v_readfirstlane_b32 s56, v20
    s_cmp_eq_u32 s57, 0
    s_cbranch_scc1 recurrent_scan__ssm_conv_h3__mixer_gmlp__prompt_kernel_lwk16
    s_cmp_ge_u32 s56, 4
    s_cbranch_scc1 recurrent_scan__ssm_conv_h3__mixer_gmlp__prompt_kernel_lwk16
    s_sleep 1
    s_branch recurrent_scan__ssm_conv_h3__mixer_gmlp__prompt_kernel_lw15
recurrent_scan__ssm_conv_h3__mixer_gmlp__prompt_kernel_lwk16:
    s_mov_b32 s41, 0
    s_lshl_b32 s41, s41, 9
    s_add_u32 m0, s60, 0
    s_add_u32 s42, s41, s62
    buffer_load_dwordx4 v6, s[8:11], s42 offen  lds
    s_add_u32 m0, s60, 1024
    s_nop 0
    buffer_load_dwordx4 v7, s[8:11], s42 offen  lds
    s_add_u32 m0, s60, 2048
    s_add_u32 s42, s41, s63
    buffer_load_dwordx4 v6, s[8:11], s42 offen  lds
    s_add_u32 m0, s60, 3072
    s_nop 0
    buffer_load_dwordx4 v7, s[8:11], s42 offen  lds
    s_add_u32 m0, s60, 4096
    s_add_u32 s42, s41, s64
    buffer_load_dwordx4 v6, s[8:11], s42 offen  lds
    s_add_u32 m0, s60, 5120
    s_nop 0
    buffer_load_dwordx4 v7, s[8:11], s42 offen  lds
    s_add_u32 m0, s60, 6144
    s_add_u32 s42, s41, s65
    buffer_load_dwordx4 v6, s[8:11], s42 offen  lds
    s_add_u32 m0, s60, 7168
    s_nop 0
    buffer_load_dwordx4 v7, s[8:11], s42 offen  lds
    s_mov_b32 s41, 1
    s_lshl_b32 s41, s41, 9
    s_add_u32 m0, s60, 8192
    s_add_u32 s42, s41, s62
    buffer_load_dwordx4 v6, s[8:11], s42 offen  lds
    s_add_u32 m0, s60, 9216
    s_nop 0
    buffer_load_dwordx4 v7, s[8:11], s42 offen  lds
    s_add_u32 m0, s60, 10240
    s_add_u32 s42, s41, s63
    buffer_load_dwordx4 v6, s[8:11], s42 offen  lds
    s_add_u32 m0, s60, 11264
    s_nop 0
    buffer_load_dwordx4 v7, s[8:11], s42 offen  lds
    s_add_u32 m0, s60, 12288
    s_add_u32 s42, s41, s64
    buffer_load_dwordx4 v6, s[8:11], s42 offen  lds
    s_add_u32 m0, s60, 13312
    s_nop 0
    buffer_load_dwordx4 v7, s[8:11], s42 offen  lds
    s_add_u32 m0, s60, 14336
    s_add_u32 s42, s41, s65
    buffer_load_dwordx4 v6, s[8:11], s42 offen  lds
    s_add_u32 m0, s60, 15360
    s_nop 0
    buffer_load_dwordx4 v7, s[8:11], s42 offen  lds
    s_waitcnt vmcnt(8)
    ds_read_b128 v[212:215], v12 offset:0
    ds_read_b128 v[216:219], v12 offset:2048
    ds_read_b128 v[220:223], v12 offset:4096
    ds_read_b128 v[224:227], v12 offset:6144
    ds_read_b128 v[228:231], v13 offset:0
    ds_read_b128 v[232:235], v13 offset:2048
    ds_read_b128 v[236:239], v13 offset:4096
    ds_read_b128 v[240:243], v13 offset:6144
    s_waitcnt lgkmcnt(0)
    s_mov_b32 s41, 2
    s_lshl_b32 s41, s41, 9
    s_add_u32 m0, s60, 0
    s_add_u32 s42, s41, s62
    buffer_load_dwordx4 v6, s[8:11], s42 offen  lds
    s_add_u32 m0, s60, 1024
    s_nop 0
    buffer_load_dwordx4 v7, s[8:11], s42 offen  lds
    s_add_u32 m0, s60, 2048
    s_add_u32 s42, s41, s63
    buffer_load_dwordx4 v6, s[8:11], s42 offen  lds
    s_add_u32 m0, s60, 3072
    s_nop 0
    buffer_load_dwordx4 v7, s[8:11], s42 offen  lds
    s_add_u32 m0, s60, 4096
    s_add_u32 s42, s41, s64
    buffer_load_dwordx4 v6, s[8:11], s42 offen  lds
    s_add_u32 m0, s60, 5120
    s_nop 0
    buffer_load_dwordx4 v7, s[8:11], s42 offen  lds
    s_add_u32 m0, s60, 6144
    s_add_u32 s42, s41, s65
    buffer_load_dwordx4 v6, s[8:11], s42 offen  lds
    s_add_u32 m0, s60, 7168
    s_nop 0
    buffer_load_dwordx4 v7, s[8:11], s42 offen  lds
    s_cmp_lg_u32 s30, 0
    s_cbranch_scc1 recurrent_scan__ssm_conv_h3__mixer_gmlp__prompt_kernel_ho13
    s_mul_i32 s40, s34, 7
    s_add_u32 s41, s40, 6
    s_lshr_b32 s40, s40, 2
    s_lshr_b32 s41, s41, 2
    s_sub_u32 s41, s41, s40
    s_lshl_b32 s41, s41, 4
    s_add_u32 s41, s41, 15
    s_lshl_b32 s40, s40, 4
    v_min_u32 v20, s41, v1
    v_add_u32 v20, s40, v20
    v_lshlrev_b32 v20, 7, v20
    s_mov_b32 s40, 139264
    s_mov_b32 exec_hi, 0xffff
    s_mov_b32 s57, 65536
recurrent_scan__ssm_conv_h3__mixer_gmlp__prompt_kernel_pl17:
    buffer_load_dword v21, v20, s[44:47], s40 offen sc1
    s_sub_u32 s57, s57, 1
    s_waitcnt vmcnt(0)
    v_cmp_ne_u32 vcc, v21, v19
    s_cmp_eq_u32 s57, 0
    s_cbranch_scc1 recurrent_scan__ssm_conv_h3__mixer_gmlp__prompt_kernel_plk18
    s_nop 2
    s_cbranch_vccz recurrent_scan__ssm_conv_h3__mixer_gmlp__prompt_kernel_plk18
    s_sleep 2
    s_branch recurrent_scan__ssm_conv_h3__mixer_gmlp__prompt_kernel_pl17
recurrent_scan__ssm_conv_h3__mixer_gmlp__prompt_kernel_plk18:
    s_mov_b64 exec, -1
    v_mov_b32 v19, 1
    ds_write_b32 v18, v19
    s_branch recurrent_scan__ssm_conv_h3__mixer_gmlp__prompt_kernel_hd14
recurrent_scan__ssm_conv_h3__mixer_gmlp__prompt_kernel_ho13:
    s_mov_b32 s57, 0x400000
recurrent_scan__ssm_conv_h3__mixer_gmlp__prompt_kernel_lw19:
    ds_read_b32 v19, v18 offset:0
    s_sub_u32 s57, s57, 1
    s_waitcnt lgkmcnt(0)
    v_readfirstlane_b32 s56, v19
    s_cmp_eq_u32 s57, 0
    s_cbranch_scc1 recurrent_scan__ssm_conv_h3__mixer_gmlp__prompt_kernel_lwk20
    s_cmp_ge_u32 s56, 1
    s_cbranch_scc1 recurrent_scan__ssm_conv_h3__mixer_gmlp__prompt_kernel_lwk20
    s_sleep 1
    s_branch recurrent_scan__ssm_conv_h3__mixer_gmlp__prompt_kernel_lw19
recurrent_scan__ssm_conv_h3__mixer_gmlp__prompt_kernel_lwk20:
recurrent_scan__ssm_conv_h3__mixer_gmlp__prompt_kernel_hd14:
    s_mov_b32 s40, 0
    s_mul_i32 s40, s40, 458752
    s_add_u32 s40, s40, s38
    s_sub_u32 s69, s40, s68
    buffer_load_dwordx4 v[128:131], v4, s[12:15], s40 offen offset:0 sc1
    buffer_load_dwordx4 v[132:135], v4, s[12:15], s40 offen offset:1024 sc1
    buffer_load_dwordx4 v[136:139], v4, s[12:15], s40 offen offset:2048 sc1
    buffer_load_dwordx4 v[140:143], v4, s[12:15], s40 offen offset:3072 sc1
    buffer_load_dwordx4 v[144:147], v5, s[12:15], s40 offen offset:0 sc1
    buffer_load_dwordx4 v[148:151], v5, s[12:15], s40 offen offset:1024 sc1
    buffer_load_dwordx4 v[152:155], v5, s[12:15], s69 offen offset:2048 sc1
    s_mov_b32 s40, 0
    s_mul_i32 s40, s40, 458752
    s_add_u32 s40, s40, s38
    s_add_u32 s40, s40, 57344
    s_sub_u32 s69, s40, s68
    buffer_load_dwordx4 v[156:159], v4, s[12:15], s40 offen offset:0 sc1
    buffer_load_dwordx4 v[160:163], v4, s[12:15], s40 offen offset:1024 sc1
    buffer_load_dwordx4 v[164:167], v4, s[12:15], s40 offen offset:2048 sc1
    buffer_load_dwordx4 v[168:171], v4, s[12:15], s40 offen offset:3072 sc1
    buffer_load_dwordx4 v[172:175], v5, s[12:15], s40 offen offset:0 sc1
    buffer_load_dwordx4 v[176:179], v5, s[12:15], s40 offen offset:1024 sc1
    buffer_load_dwordx4 v[180:183], v5, s[12:15], s69 offen offset:2048 sc1
    s_mov_b32 s40, 1
    s_mul_i32 s40, s40, 458752
    s_add_u32 s40, s40, s38
    s_sub_u32 s69, s40, s68
    s_waitcnt vmcnt(13)
    v_mfma_f32_16x16x32_bf16 v[16:19], v[128:131], v[212:215], 0
    v_mfma_f32_16x16x32_bf16 v[20:23], v[128:131], v[216:219], 0
    v_mfma_f32_16x16x32_bf16 v[24:27], v[128:131], v[220:223], 0
    v_mfma_f32_16x16x32_bf16 v[28:31], v[128:131], v[224:227], 0
    buffer_load_dwordx4 v[184:187], v4, s[12:15], s40 offen offset:0 sc1
    s_waitcnt vmcnt(13)
    v_mfma_f32_16x16x32_bf16 v[32:35], v[132:135], v[212:215], 0
    v_mfma_f32_16x16x32_bf16 v[36:39], v[132:135], v[216:219], 0
    v_mfma_f32_16x16x32_bf16 v[40:43], v[132:135], v[220:223], 0
    v_mfma_f32_16x16x32_bf16 v[44:47], v[132:135], v[224:227], 0
    buffer_load_dwordx4 v[188:191], v4, s[12:15], s40 offen offset:1024 sc1
    s_waitcnt vmcnt(13)
    v_mfma_f32_16x16x32_bf16 v[48:51], v[136:139], v[212:215], 0
    v_mfma_f32_16x16x32_bf16 v[52:55], v[136:139], v[216:219], 0
    v_mfma_f32_16x16x32_bf16 v[56:59], v[136:139], v[220:223], 0
    v_mfma_f32_16x16x32_bf16 v[60:63], v[136:139], v[224:227], 0
    buffer_load_dwordx4 v[192:195], v4, s[12:15], s40 offen offset:2048 sc1
    s_waitcnt vmcnt(13)
    v_mfma_f32_16x16x32_bf16 v[64:67], v[140:143], v[212:215], 0
    v_mfma_f32_16x16x32_bf16 v[68:71], v[140:143], v[216:219], 0
    v_mfma_f32_16x16x32_bf16 v[72:75], v[140:143], v[220:223], 0
    v_mfma_f32_16x16x32_bf16 v[76:79], v[140:143], v[224:227], 0
    buffer_load_dwordx4 v[196:199], v4, s[12:15], s40 offen offset:3072 sc1
    s_waitcnt vmcnt(13)
    v_mfma_f32_16x16x32_bf16 v[80:83], v[144:147], v[212:215], 0
    v_mfma_f32_16x16x32_bf16 v[84:87], v[144:147], v[216:219], 0
    v_mfma_f32_16x16x32_bf16 v[88:91], v[144:147], v[220:223], 0
    v_mfma_f32_16x16x32_bf16 v[92:95], v[144:147], v[224:227], 0
    buffer_load_dwordx4 v[200:203], v5, s[12:15], s40 offen offset:0 sc1
    s_waitcnt vmcnt(13)
    v_mfma_f32_16x16x32_bf16 v[96:99], v[148:151], v[212:215], 0
    v_mfma_f32_16x16x32_bf16 v[100:103], v[148:151], v[216:219], 0
    v_mfma_f32_16x16x32_bf16 v[104:107], v[148:151], v[220:223], 0
    v_mfma_f32_16x16x32_bf16 v[108:111], v[148:151], v[224:227], 0
    buffer_load_dwordx4 v[204:207], v5, s[12:15], s40 offen offset:1024 sc1
    s_waitcnt vmcnt(13)
    v_mfma_f32_16x16x32_bf16 v[112:115], v[152:155], v[212:215], 0
    v_mfma_f32_16x16x32_bf16 v[116:119], v[152:155], v[216:219], 0
    v_mfma_f32_16x16x32_bf16 v[120:123], v[152:155], v[220:223], 0
    v_mfma_f32_16x16x32_bf16 v[124:127], v[152:155], v[224:227], 0
    buffer_load_dwordx4 v[208:211], v5, s[12:15], s69 offen offset:2048 sc1
    s_waitcnt vmcnt(29)
    ds_read_b128 v[212:215], v12 offset:8192
    ds_read_b128 v[216:219], v12 offset:10240
    ds_read_b128 v[220:223], v12 offset:12288
    ds_read_b128 v[224:227], v12 offset:14336
    s_waitcnt lgkmcnt(4)
    s_mov_b32 s40, 1
    s_mul_i32 s40, s40, 458752
    s_add_u32 s40, s40, s38
    s_add_u32 s40, s40, 57344
    s_sub_u32 s69, s40, s68
    s_waitcnt vmcnt(13)
    v_mfma_f32_16x16x32_bf16 v[16:19], v[156:159], v[228:231], v[16:19]
    v_mfma_f32_16x16x32_bf16 v[20:23], v[156:159], v[232:235], v[20:23]
    v_mfma_f32_16x16x32_bf16 v[24:27], v[156:159], v[236:239], v[24:27]
    v_mfma_f32_16x16x32_bf16 v[28:31], v[156:159], v[240:243], v[28:31]
    buffer_load_dwordx4 v[128:131], v4, s[12:15], s40 offen offset:0 sc1
    s_waitcnt vmcnt(13)
    v_mfma_f32_16x16x32_bf16 v[32:35], v[160:163], v[228:231], v[32:35]
    v_mfma_f32_16x16x32_bf16 v[36:39], v[160:163], v[232:235], v[36:39]
    v_mfma_f32_16x16x32_bf16 v[40:43], v[160:163], v[236:239], v[40:43]
    v_mfma_f32_16x16x32_bf16 v[44:47], v[160:163], v[240:243], v[44:47]
    buffer_load_dwordx4 v[132:135], v4, s[12:15], s40 offen offset:1024 sc1
    s_waitcnt vmcnt(13)
    v_mfma_f32_16x16x32_bf16 v[48:51], v[164:167], v[228:231], v[48:51]
    v_mfma_f32_16x16x32_bf16 v[52:55], v[164:167], v[232:235], v[52:55]
    v_mfma_f32_16x16x32_bf16 v[56:59], v[164:167], v[236:239], v[56:59]
    v_mfma_f32_16x16x32_bf16 v[60:63], v[164:167], v[240:243], v[60:63]
    buffer_load_dwordx4 v[136:139], v4, s[12:15], s40 offen offset:2048 sc1
    s_waitcnt vmcnt(13)
    v_mfma_f32_16x16x32_bf16 v[64:67], v[168:171], v[228:231], v[64:67]
    v_mfma_f32_16x16x32_bf16 v[68:71], v[168:171], v[232:235], v[68:71]
    v_mfma_f32_16x16x32_bf16 v[72:75], v[168:171], v[236:239], v[72:75]
    v_mfma_f32_16x16x32_bf16 v[76:79], v[168:171], v[240:243], v[76:79]
    buffer_load_dwordx4 v[140:143], v4, s[12:15], s40 offen offset:3072 sc1
    s_waitcnt vmcnt(13)
    v_mfma_f32_16x16x32_bf16 v[80:83], v[172:175], v[228:231], v[80:83]
    v_mfma_f32_16x16x32_bf16 v[84:87], v[172:175], v[232:235], v[84:87]
    v_mfma_f32_16x16x32_bf16 v[88:91], v[172:175], v[236:239], v[88:91]
    v_mfma_f32_16x16x32_bf16 v[92:95], v[172:175], v[240:243], v[92:95]
    buffer_load_dwordx4 v[144:147], v5, s[12:15], s40 offen offset:0 sc1
    s_waitcnt vmcnt(13)
    v_mfma_f32_16x16x32_bf16 v[96:99], v[176:179], v[228:231], v[96:99]
    v_mfma_f32_16x16x32_bf16 v[100:103], v[176:179], v[232:235], v[100:103]
    v_mfma_f32_16x16x32_bf16 v[104:107], v[176:179], v[236:239], v[104:107]
    v_mfma_f32_16x16x32_bf16 v[108:111], v[176:179], v[240:243], v[108:111]
    buffer_load_dwordx4 v[148:151], v5, s[12:15], s40 offen offset:1024 sc1
    s_waitcnt vmcnt(13)
    v_mfma_f32_16x16x32_bf16 v[112:115], v[180:183], v[228:231], v[112:115]
    v_mfma_f32_16x16x32_bf16 v[116:119], v[180:183], v[232:235], v[116:119]
    v_mfma_f32_16x16x32_bf16 v[120:123], v[180:183], v[236:239], v[120:123]
    v_mfma_f32_16x16x32_bf16 v[124:127], v[180:183], v[240:243], v[124:127]
    buffer_load_dwordx4 v[152:155], v5, s[12:15], s69 offen offset:2048 sc1
    ds_read_b128 v[228:231], v13 offset:8192
    ds_read_b128 v[232:235], v13 offset:10240
    ds_read_b128 v[236:239], v13 offset:12288
    ds_read_b128 v[240:243], v13 offset:14336
    s_waitcnt lgkmcnt(4)
    s_mov_b32 s40, 2
    s_mul_i32 s40, s40, 458752
    s_add_u32 s40, s40, s38
    s_sub_u32 s69, s40, s68
    v_mov_b32 v0, 163328
    s_mov_b32 s57, 0x400000
recurrent_scan__ssm_conv_h3__mixer_gmlp__prompt_kernel_lw21:
    ds_read_b32 v1, v0 offset:28
    s_sub_u32 s57, s57, 1
    s_waitcnt lgkmcnt(0)
    v_readfirstlane_b32 s56, v1
    s_cmp_eq_u32 s57, 0
    s_cbranch_scc1 recurrent_scan__ssm_conv_h3__mixer_gmlp__prompt_kernel_lwk22
    s_cmp_ge_u32 s56, 1
    s_cbranch_scc1 recurrent_scan__ssm_conv_h3__mixer_gmlp__prompt_kernel_lwk22
    s_sleep 1
    s_branch recurrent_scan__ssm_conv_h3__mixer_gmlp__prompt_kernel_lw21
recurrent_scan__ssm_conv_h3__mixer_gmlp__prompt_kernel_lwk22:
    s_lshl_b32 s41, s33, 2
    s_add_u32 s41, s41, s30
    s_mul_i32 s42, s41, 28672
    s_mul_i32 s43, s34, 7
    s_add_u32 s43, s43, s67
    s_lshl_b32 s43, s43, 9
    s_add_u32 s50, s42, s43
    s_mul_i32 s44, s67, 4088
    s_add_u32 s51, s50, 3072
    s_sub_u32 s51, s51, s44
    buffer_load_dwordx4 v[244:247], v4, s[16:19], s50 offen offset:0 sc1
    buffer_load_dwordx4 v[248:251], v4, s[16:19], s50 offen offset:1024 sc1
    buffer_load_dwordx4 v[252:255], v4, s[16:19], s50 offen offset:2048 sc1
    buffer_load_dwordx2 v[14:15], v4, s[16:19], s51 offen sc1
    s_lshl_b32 s46, s41, 5
    v_lshlrev_b32 v10, 1, v2
    buffer_load_ushort v11, v10, s[24:27], s46 offen
    s_mov_b32 s49, 0xffff0000
    s_waitcnt vmcnt(18)
    v_mfma_f32_16x16x32_bf16 v[16:19], v[184:187], v[212:215], v[16:19]
    v_mfma_f32_16x16x32_bf16 v[20:23], v[184:187], v[216:219], v[20:23]
    v_mfma_f32_16x16x32_bf16 v[24:27], v[184:187], v[220:223], v[24:27]
    v_mfma_f32_16x16x32_bf16 v[28:31], v[184:187], v[224:227], v[28:31]
    buffer_load_dwordx4 v[156:159], v4, s[12:15], s40 offen offset:0 sc1
    s_waitcnt vmcnt(18)
    v_mfma_f32_16x16x32_bf16 v[32:35], v[188:191], v[212:215], v[32:35]
    v_mfma_f32_16x16x32_bf16 v[36:39], v[188:191], v[216:219], v[36:39]
    v_mfma_f32_16x16x32_bf16 v[40:43], v[188:191], v[220:223], v[40:43]
    v_mfma_f32_16x16x32_bf16 v[44:47], v[188:191], v[224:227], v[44:47]
    buffer_load_dwordx4 v[160:163], v4, s[12:15], s40 offen offset:1024 sc1
    s_waitcnt vmcnt(18)
    v_mfma_f32_16x16x32_bf16 v[48:51], v[192:195], v[212:215], v[48:51]
    v_mfma_f32_16x16x32_bf16 v[52:55], v[192:195], v[216:219], v[52:55]
    v_mfma_f32_16x16x32_bf16 v[56:59], v[192:195], v[220:223], v[56:59]
    v_mfma_f32_16x16x32_bf16 v[60:63], v[192:195], v[224:227], v[60:63]
    buffer_load_dwordx4 v[164:167], v4, s[12:15], s40 offen offset:2048 sc1
    s_waitcnt vmcnt(18)
    v_mfma_f32_16x16x32_bf16 v[64:67], v[196:199], v[212:215], v[64:67]
    v_mfma_f32_16x16x32_bf16 v[68:71], v[196:199], v[216:219], v[68:71]
    v_mfma_f32_16x16x32_bf16 v[72:75], v[196:199], v[220:223], v[72:75]
    v_mfma_f32_16x16x32_bf16 v[76:79], v[196:199], v[224:227], v[76:79]
    buffer_load_dwordx4 v[168:171], v4, s[12:15], s40 offen offset:3072 sc1
    s_waitcnt vmcnt(18)
    v_mfma_f32_16x16x32_bf16 v[80:83], v[200:203], v[212:215], v[80:83]
    v_mfma_f32_16x16x32_bf16 v[84:87], v[200:203], v[216:219], v[84:87]
    v_mfma_f32_16x16x32_bf16 v[88:91], v[200:203], v[220:223], v[88:91]
    v_mfma_f32_16x16x32_bf16 v[92:95], v[200:203], v[224:227], v[92:95]
    buffer_load_dwordx4 v[172:175], v5, s[12:15], s40 offen offset:0 sc1
    s_waitcnt vmcnt(18)
    v_mfma_f32_16x16x32_bf16 v[96:99], v[204:207], v[212:215], v[96:99]
    v_mfma_f32_16x16x32_bf16 v[100:103], v[204:207], v[216:219], v[100:103]
    v_mfma_f32_16x16x32_bf16 v[104:107], v[204:207], v[220:223], v[104:107]
    v_mfma_f32_16x16x32_bf16 v[108:111], v[204:207], v[224:227], v[108:111]
    buffer_load_dwordx4 v[176:179], v5, s[12:15], s40 offen offset:1024 sc1
    s_waitcnt vmcnt(18)
    v_mfma_f32_16x16x32_bf16 v[112:115], v[208:211], v[212:215], v[112:115]
    v_mfma_f32_16x16x32_bf16 v[116:119], v[208:211], v[216:219], v[116:119]
    v_mfma_f32_16x16x32_bf16 v[120:123], v[208:211], v[220:223], v[120:123]
    v_mfma_f32_16x16x32_bf16 v[124:127], v[208:211], v[224:227], v[124:127]
    buffer_load_dwordx4 v[180:183], v5, s[12:15], s69 offen offset:2048 sc1
    s_waitcnt vmcnt(40)
    ds_read_b128 v[212:215], v12 offset:0
    ds_read_b128 v[216:219], v12 offset:2048
    ds_read_b128 v[220:223], v12 offset:4096
    ds_read_b128 v[224:227], v12 offset:6144
    s_waitcnt lgkmcnt(4)
    s_mov_b32 s41, 3
    s_lshl_b32 s41, s41, 9
    s_mov_b32 s40, 2
    s_mul_i32 s40, s40, 458752
    s_add_u32 s40, s40, s38
    s_add_u32 s40, s40, 57344
    s_sub_u32 s69, s40, s68
    s_waitcnt vmcnt(18)
    v_mfma_f32_16x16x32_bf16 v[16:19], v[128:131], v[228:231], v[16:19]
    v_mfma_f32_16x16x32_bf16 v[20:23], v[128:131], v[232:235], v[20:23]
    s_add_u32 m0, s60, 8192
    s_add_u32 s42, s41, s62
    buffer_load_dwordx4 v6, s[8:11], s42 offen  lds
    v_mfma_f32_16x16x32_bf16 v[24:27], v[128:131], v[236:239], v[24:27]
    v_mfma_f32_16x16x32_bf16 v[28:31], v[128:131], v[240:243], v[28:31]
    buffer_load_dwordx4 v[184:187], v4, s[12:15], s40 offen offset:0 sc1
    s_waitcnt vmcnt(19)
    v_mfma_f32_16x16x32_bf16 v[32:35], v[132:135], v[228:231], v[32:35]
    v_mfma_f32_16x16x32_bf16 v[36:39], v[132:135], v[232:235], v[36:39]
    s_add_u32 m0, s60, 9216
    s_nop 0
    buffer_load_dwordx4 v7, s[8:11], s42 offen  lds
    v_mfma_f32_16x16x32_bf16 v[40:43], v[132:135], v[236:239], v[40:43]
    v_mfma_f32_16x16x32_bf16 v[44:47], v[132:135], v[240:243], v[44:47]
    buffer_load_dwordx4 v[188:191], v4, s[12:15], s40 offen offset:1024 sc1
    s_waitcnt vmcnt(20)
    v_mfma_f32_16x16x32_bf16 v[48:51], v[136:139], v[228:231], v[48:51]
    v_mfma_f32_16x16x32_bf16 v[52:55], v[136:139], v[232:235], v[52:55]
    s_add_u32 m0, s60, 10240
    s_add_u32 s42, s41, s63
    buffer_load_dwordx4 v6, s[8:11], s42 offen  lds
    v_mfma_f32_16x16x32_bf16 v[56:59], v[136:139], v[236:239], v[56:59]
    v_mfma_f32_16x16x32_bf16 v[60:63], v[136:139], v[240:243], v[60:63]
    buffer_load_dwordx4 v[192:195], v4, s[12:15], s40 offen offset:2048 sc1
    s_waitcnt vmcnt(21)
    v_mfma_f32_16x16x32_bf16 v[64:67], v[140:143], v[228:231], v[64:67]
    v_mfma_f32_16x16x32_bf16 v[68:71], v[140:143], v[232:235], v[68:71]
    s_add_u32 m0, s60, 11264
    s_nop 0
    buffer_load_dwordx4 v7, s[8:11], s42 offen  lds
    v_mfma_f32_16x16x32_bf16 v[72:75], v[140:143], v[236:239], v[72:75]
    v_mfma_f32_16x16x32_bf16 v[76:79], v[140:143], v[240:243], v[76:79]
    buffer_load_dwordx4 v[196:199], v4, s[12:15], s40 offen offset:3072 sc1
    s_waitcnt vmcnt(22)
    v_mfma_f32_16x16x32_bf16 v[80:83], v[144:147], v[228:231], v[80:83]
    v_mfma_f32_16x16x32_bf16 v[84:87], v[144:147], v[232:235], v[84:87]
    s_add_u32 m0, s60, 12288
    s_add_u32 s42, s41, s64
    buffer_load_dwordx4 v6, s[8:11], s42 offen  lds
    v_mfma_f32_16x16x32_bf16 v[88:91], v[144:147], v[236:239], v[88:91]
    v_mfma_f32_16x16x32_bf16 v[92:95], v[144:147], v[240:243], v[92:95]
    buffer_load_dwordx4 v[200:203], v5, s[12:15], s40 offen offset:0 sc1
    s_waitcnt vmcnt(23)
    v_mfma_f32_16x16x32_bf16 v[96:99], v[148:151], v[228:231], v[96:99]
    v_mfma_f32_16x16x32_bf16 v[100:103], v[148:151], v[232:235], v[100:103]
    s_add_u32 m0, s60, 13312
    s_nop 0
    buffer_load_dwordx4 v7, s[8:11], s42 offen  lds
    v_mfma_f32_16x16x32_bf16 v[104:107], v[148:151], v[236:239], v[104:107]
    v_mfma_f32_16x16x32_bf16 v[108:111], v[148:151], v[240:243], v[108:111]
    buffer_load_dwordx4 v[204:207], v5, s[12:15], s40 offen offset:1024 sc1
    s_waitcnt vmcnt(24)
    v_mfma_f32_16x16x32_bf16 v[112:115], v[152:155], v[228:231], v[112:115]
    v_mfma_f32_16x16x32_bf16 v[116:119], v[152:155], v[232:235], v[116:119]
    s_add_u32 m0, s60, 14336
    s_add_u32 s42, s41, s65
    buffer_load_dwordx4 v6, s[8:11], s42 offen  lds
    v_mfma_f32_16x16x32_bf16 v[120:123], v[152:155], v[236:239], v[120:123]
    v_mfma_f32_16x16x32_bf16 v[124:127], v[152:155], v[240:243], v[124:127]
    s_add_u32 m0, s60, 15360
    s_nop 0
    buffer_load_dwordx4 v7, s[8:11], s42 offen  lds
    buffer_load_dwordx4 v[208:211], v5, s[12:15], s69 offen offset:2048 sc1
    ds_read_b128 v[228:231], v13 offset:0
    ds_read_b128 v[232:235], v13 offset:2048
    ds_read_b128 v[236:239], v13 offset:4096
    ds_read_b128 v[240:243], v13 offset:6144
    s_waitcnt lgkmcnt(4)
    s_mov_b32 s40, 3
    s_mul_i32 s40, s40, 458752
    s_add_u32 s40, s40, s38
    s_sub_u32 s69, s40, s68
    s_waitcnt vmcnt(21)
    v_mfma_f32_16x16x32_bf16 v[16:19], v[156:159], v[212:215], v[16:19]
    v_mfma_f32_16x16x32_bf16 v[20:23], v[156:159], v[216:219], v[20:23]
    v_mfma_f32_16x16x32_bf16 v[24:27], v[156:159], v[220:223], v[24:27]
    v_mfma_f32_16x16x32_bf16 v[28:31], v[156:159], v[224:227], v[28:31]
    buffer_load_dwordx4 v[128:131], v4, s[12:15], s40 offen offset:0 sc1
    s_waitcnt vmcnt(21)
    v_mfma_f32_16x16x32_bf16 v[32:35], v[160:163], v[212:215], v[32:35]
    v_mfma_f32_16x16x32_bf16 v[36:39], v[160:163], v[216:219], v[36:39]
    v_mfma_f32_16x16x32_bf16 v[40:43], v[160:163], v[220:223], v[40:43]
    v_mfma_f32_16x16x32_bf16 v[44:47], v[160:163], v[224:227], v[44:47]
    buffer_load_dwordx4 v[132:135], v4, s[12:15], s40 offen offset:1024 sc1
    s_waitcnt vmcnt(21)
    v_mfma_f32_16x16x32_bf16 v[48:51], v[164:167], v[212:215], v[48:51]
    v_mfma_f32_16x16x32_bf16 v[52:55], v[164:167], v[216:219], v[52:55]
    v_mfma_f32_16x16x32_bf16 v[56:59], v[164:167], v[220:223], v[56:59]
    v_mfma_f32_16x16x32_bf16 v[60:63], v[164:167], v[224:227], v[60:63]
    buffer_load_dwordx4 v[136:139], v4, s[12:15], s40 offen offset:2048 sc1
    s_waitcnt vmcnt(21)
    v_mfma_f32_16x16x32_bf16 v[64:67], v[168:171], v[212:215], v[64:67]
    v_mfma_f32_16x16x32_bf16 v[68:71], v[168:171], v[216:219], v[68:71]
    v_mfma_f32_16x16x32_bf16 v[72:75], v[168:171], v[220:223], v[72:75]
    v_mfma_f32_16x16x32_bf16 v[76:79], v[168:171], v[224:227], v[76:79]
    buffer_load_dwordx4 v[140:143], v4, s[12:15], s40 offen offset:3072 sc1
    s_waitcnt vmcnt(21)
    v_mfma_f32_16x16x32_bf16 v[80:83], v[172:175], v[212:215], v[80:83]
    v_mfma_f32_16x16x32_bf16 v[84:87], v[172:175], v[216:219], v[84:87]
    v_mfma_f32_16x16x32_bf16 v[88:91], v[172:175], v[220:223], v[88:91]
    v_mfma_f32_16x16x32_bf16 v[92:95], v[172:175], v[224:227], v[92:95]
    buffer_load_dwordx4 v[144:147], v5, s[12:15], s40 offen offset:0 sc1
    s_waitcnt vmcnt(21)
    v_mfma_f32_16x16x32_bf16 v[96:99], v[176:179], v[212:215], v[96:99]
    v_mfma_f32_16x16x32_bf16 v[100:103], v[176:179], v[216:219], v[100:103]
    v_mfma_f32_16x16x32_bf16 v[104:107], v[176:179], v[220:223], v[104:107]
    v_mfma_f32_16x16x32_bf16 v[108:111], v[176:179], v[224:227], v[108:111]
    buffer_load_dwordx4 v[148:151], v5, s[12:15], s40 offen offset:1024 sc1
    s_waitcnt vmcnt(21)
    v_mfma_f32_16x16x32_bf16 v[112:115], v[180:183], v[212:215], v[112:115]
    v_mfma_f32_16x16x32_bf16 v[116:119], v[180:183], v[216:219], v[116:119]
    v_mfma_f32_16x16x32_bf16 v[120:123], v[180:183], v[220:223], v[120:123]
    v_mfma_f32_16x16x32_bf16 v[124:127], v[180:183], v[224:227], v[124:127]
    buffer_load_dwordx4 v[152:155], v5, s[12:15], s69 offen offset:2048 sc1
    s_waitcnt vmcnt(8)
    ds_read_b128 v[212:215], v12 offset:8192
    ds_read_b128 v[216:219], v12 offset:10240
    ds_read_b128 v[220:223], v12 offset:12288
    ds_read_b128 v[224:227], v12 offset:14336
    s_waitcnt lgkmcnt(4)
    s_mov_b32 s41, 4
    s_lshl_b32 s41, s41, 9
    s_mov_b32 s40, 3
    s_mul_i32 s40, s40, 458752
    s_add_u32 s40, s40, s38
    s_add_u32 s40, s40, 57344
    s_sub_u32 s69, s40, s68
    s_waitcnt vmcnt(29)
    s_waitcnt vmcnt(20)
    v_mfma_f32_16x16x32_bf16 v[16:19], v[184:187], v[228:231], v[16:19]
    v_lshlrev_b32 v0, 16, v244
    v_and_b32 v1, s49, v244
    v_mfma_f32_16x16x32_bf16 v[20:23], v[184:187], v[232:235], v[20:23]
    v_fmaak_f32 v8, v0, v0, 0x41b2e92f
    v_fmaak_f32 v9, v1, v1, 0x41b2e92f
    s_add_u32 m0, s60, 0
    s_add_u32 s42, s41, s62
    buffer_load_dwordx4 v6, s[8:11], s42 offen  lds
    v_mfma_f32_16x16x32_bf16 v[24:27], v[184:187], v[236:239], v[24:27]
    v_mul_f32 v8, v8, v0
    v_mul_f32 v9, v9, v1
    v_mfma_f32_16x16x32_bf16 v[28:31], v[184:187], v[240:243], v[28:31]
    v_mul_f32 v8, 0xbdd2d3e8, v8
    v_mul_f32 v9, 0xbdd2d3e8, v9
    buffer_load_dwordx4 v[156:159], v4, s[12:15], s40 offen offset:0 sc1
    s_waitcnt vmcnt(20)
    v_mfma_f32_16x16x32_bf16 v[32:35], v[188:191], v[228:231], v[32:35]
    v_exp_f32 v8, v8
    v_exp_f32 v9, v9
    v_mfma_f32_16x16x32_bf16 v[36:39], v[188:191], v[232:235], v[36:39]
    s_nop 0
    v_add_f32 v8, 1.0, v8
    s_add_u32 m0, s60, 1024
    s_nop 0
    buffer_load_dwordx4 v7, s[8:11], s42 offen  lds
    v_mfma_f32_16x16x32_bf16 v[40:43], v[188:191], v[236:239], v[40:43]
    v_add_f32 v9, 1.0, v9
    v_rcp_f32 v8, v8
    v_mfma_f32_16x16x32_bf16 v[44:47], v[188:191], v[240:243], v[44:47]
    v_rcp_f32 v9, v9
    s_nop 0
    buffer_load_dwordx4 v[160:163], v4, s[12:15], s40 offen offset:1024 sc1
    s_waitcnt vmcnt(20)
    v_mfma_f32_16x16x32_bf16 v[48:51], v[192:195], v[228:231], v[48:51]
    v_mul_f32 v0, v0, v8
    v_mul_f32 v1, v1, v9
    v_mfma_f32_16x16x32_bf16 v[52:55], v[192:195], v[232:235], v[52:55]
    v_cvt_pk_bf16_f32 v244, v0, v1
    v_lshlrev_b32 v0, 16, v245
    s_add_u32 m0, s60, 2048
    s_add_u32 s42, s41, s63
    buffer_load_dwordx4 v6, s[8:11], s42 offen  lds
    v_mfma_f32_16x16x32_bf16 v[56:59], v[192:195], v[236:239], v[56:59]
    v_and_b32 v1, s49, v245
    v_mfma_f32_16x16x32_bf16 v[60:63], v[192:195], v[240:243], v[60:63]
    v_fmaak_f32 v8, v0, v0, 0x41b2e92f
    buffer_load_dwordx4 v[164:167], v4, s[12:15], s40 offen offset:2048 sc1
    s_waitcnt vmcnt(20)
    v_mfma_f32_16x16x32_bf16 v[64:67], v[196:199], v[228:231], v[64:67]
    v_fmaak_f32 v9, v1, v1, 0x41b2e92f
    v_mfma_f32_16x16x32_bf16 v[68:71], v[196:199], v[232:235], v[68:71]
    v_mul_f32 v8, v8, v0
    s_add_u32 m0, s60, 3072
    s_nop 0
    buffer_load_dwordx4 v7, s[8:11], s42 offen  lds
    v_mfma_f32_16x16x32_bf16 v[72:75], v[196:199], v[236:239], v[72:75]
    v_mul_f32 v9, v9, v1
    v_mfma_f32_16x16x32_bf16 v[76:79], v[196:199], v[240:243], v[76:79]
    v_mul_f32 v8, 0xbdd2d3e8, v8
    buffer_load_dwordx4 v[168:171], v4, s[12:15], s40 offen offset:3072 sc1
    s_waitcnt vmcnt(20)
    v_mfma_f32_16x16x32_bf16 v[80:83], v[200:203], v[228:231], v[80:83]
    v_mul_f32 v9, 0xbdd2d3e8, v9
    v_mfma_f32_16x16x32_bf16 v[84:87], v[200:203], v[232:235], v[84:87]
    v_exp_f32 v8, v8
    s_add_u32 m0, s60, 4096
    s_add_u32 s42, s41, s64
    buffer_load_dwordx4 v6, s[8:11], s42 offen  lds
    v_mfma_f32_16x16x32_bf16 v[88:91], v[200:203], v[236:239], v[88:91]
    v_exp_f32 v9, v9
    v_mfma_f32_16x16x32_bf16 v[92:95], v[200:203], v[240:243], v[92:95]
    s_nop 0
    buffer_load_dwordx4 v[172:175], v5, s[12:15], s40 offen offset:0 sc1
    s_waitcnt vmcnt(20)
    v_mfma_f32_16x16x32_bf16 v[96:99], v[204:207], v[228:231], v[96:99]
    v_add_f32 v8, 1.0, v8
    v_mfma_f32_16x16x32_bf16 v[100:103], v[204:207], v[232:235], v[100:103]
    v_add_f32 v9, 1.0, v9
    s_add_u32 m0, s60, 5120
    s_nop 0
    buffer_load_dwordx4 v7, s[8:11], s42 offen  lds
    v_mfma_f32_16x16x32_bf16 v[104:107], v[204:207], v[236:239], v[104:107]
    v_rcp_f32 v8, v8
    v_mfma_f32_16x16x32_bf16 v[108:111], v[204:207], v[240:243], v[108:111]
    v_rcp_f32 v9, v9
    buffer_load_dwordx4 v[176:179], v5, s[12:15], s40 offen offset:1024 sc1
    s_waitcnt vmcnt(19)
    v_mfma_f32_16x16x32_bf16 v[112:115], v[208:211], v[228:231], v[112:115]
    s_nop 0
    v_mfma_f32_16x16x32_bf16 v[116:119], v[208:211], v[232:235], v[116:119]
    v_mul_f32 v0, v0, v8
    s_add_u32 m0, s60, 6144
    s_add_u32 s42, s41, s65
    buffer_load_dwordx4 v6, s[8:11], s42 offen  lds
    v_mfma_f32_16x16x32_bf16 v[120:123], v[208:211], v[236:239], v[120:123]
    v_mul_f32 v1, v1, v9
    v_mfma_f32_16x16x32_bf16 v[124:127], v[208:211], v[240:243], v[124:127]
    v_cvt_pk_bf16_f32 v245, v0, v1
    s_add_u32 m0, s60, 7168
    s_nop 0
    buffer_load_dwordx4 v7, s[8:11], s42 offen  lds
    buffer_load_dwordx4 v[180:183], v5, s[12:15], s69 offen offset:2048 sc1
    ds_read_b128 v[228:231], v13 offset:8192
    ds_read_b128 v[232:235], v13 offset:10240
    ds_read_b128 v[236:239], v13 offset:12288
    ds_read_b128 v[240:243], v13 offset:14336
    s_waitcnt lgkmcnt(4)
    s_mov_b32 s40, 4
    s_mul_i32 s40, s40, 458752
    s_add_u32 s40, s40, s38
    s_sub_u32 s69, s40, s68
    s_waitcnt vmcnt(21)
    v_mfma_f32_16x16x32_bf16 v[16:19], v[128:131], v[212:215], v[16:19]
    v_lshlrev_b32 v0, 16, v246
    v_and_b32 v1, s49, v246
    v_mfma_f32_16x16x32_bf16 v[20:23], v[128:131], v[216:219], v[20:23]
    v_fmaak_f32 v8, v0, v0, 0x41b2e92f
    v_fmaak_f32 v9, v1, v1, 0x41b2e92f
    v_mfma_f32_16x16x32_bf16 v[24:27], v[128:131], v[220:223], v[24:27]
    v_mul_f32 v8, v8, v0
    v_mul_f32 v9, v9, v1
    v_mfma_f32_16x16x32_bf16 v[28:31], v[128:131], v[224:227], v[28:31]
    v_mul_f32 v8, 0xbdd2d3e8, v8
    v_mul_f32 v9, 0xbdd2d3e8, v9
    buffer_load_dwordx4 v[184:187], v4, s[12:15], s40 offen offset:0 sc1
    s_waitcnt vmcnt(21)
    v_mfma_f32_16x16x32_bf16 v[32:35], v[132:135], v[212:215], v[32:35]
    v_exp_f32 v8, v8
    v_exp_f32 v9, v9
    v_mfma_f32_16x16x32_bf16 v[36:39], v[132:135], v[216:219], v[36:39]
    s_nop 0
    v_add_f32 v8, 1.0, v8
    v_mfma_f32_16x16x32_bf16 v[40:43], v[132:135], v[220:223], v[40:43]
    v_add_f32 v9, 1.0, v9
    v_rcp_f32 v8, v8
    v_mfma_f32_16x16x32_bf16 v[44:47], v[132:135], v[224:227], v[44:47]
    v_rcp_f32 v9, v9
    s_nop 0
    buffer_load_dwordx4 v[188:191], v4, s[12:15], s40 offen offset:1024 sc1
    s_waitcnt vmcnt(21)
    v_mfma_f32_16x16x32_bf16 v[48:51], v[136:139], v[212:215], v[48:51]
    v_mul_f32 v0, v0, v8
    v_mul_f32 v1, v1, v9
    v_mfma_f32_16x16x32_bf16 v[52:55], v[136:139], v[216:219], v[52:55]
    v_cvt_pk_bf16_f32 v246, v0, v1
    v_lshlrev_b32 v0, 16, v247
    v_mfma_f32_16x16x32_bf16 v[56:59], v[136:139], v[220:223], v[56:59]
    v_and_b32 v1, s49, v247
    v_mfma_f32_16x16x32_bf16 v[60:63], v[136:139], v[224:227], v[60:63]
    v_fmaak_f32 v8, v0, v0, 0x41b2e92f
    buffer_load_dwordx4 v[192:195], v4, s[12:15], s40 offen offset:2048 sc1
    s_waitcnt vmcnt(21)
    v_mfma_f32_16x16x32_bf16 v[64:67], v[140:143], v[212:215], v[64:67]
    v_fmaak_f32 v9, v1, v1, 0x41b2e92f
    v_mfma_f32_16x16x32_bf16 v[68:71], v[140:143], v[216:219], v[68:71]
    v_mul_f32 v8, v8, v0
    v_mfma_f32_16x16x32_bf16 v[72:75], v[140:143], v[220:223], v[72:75]
    v_mul_f32 v9, v9, v1
    v_mfma_f32_16x16x32_bf16 v[76:79], v[140:143], v[224:227], v[76:79]
    v_mul_f32 v8, 0xbdd2d3e8, v8
    buffer_load_dwordx4 v[196:199], v4, s[12:15], s40 offen offset:3072 sc1
    s_waitcnt vmcnt(21)
    v_mfma_f32_16x16x32_bf16 v[80:83], v[144:147], v[212:215], v[80:83]
    v_mul_f32 v9, 0xbdd2d3e8, v9
    v_mfma_f32_16x16x32_bf16 v[84:87], v[144:147], v[216:219], v[84:87]
    v_exp_f32 v8, v8
    v_mfma_f32_16x16x32_bf16 v[88:91], v[144:147], v[220:223], v[88:91]
    v_exp_f32 v9, v9
    v_mfma_f32_16x16x32_bf16 v[92:95], v[144:147], v[224:227], v[92:95]
    s_nop 0
    buffer_load_dwordx4 v[200:203], v5, s[12:15], s40 offen offset:0 sc1
    s_waitcnt vmcnt(21)
    v_mfma_f32_16x16x32_bf16 v[96:99], v[148:151], v[212:215], v[96:99]
    v_add_f32 v8, 1.0, v8
    v_mfma_f32_16x16x32_bf16 v[100:103], v[148:151], v[216:219], v[100:103]
    v_add_f32 v9, 1.0, v9
    v_mfma_f32_16x16x32_bf16 v[104:107], v[148:151], v[220:223], v[104:107]
    v_rcp_f32 v8, v8
    v_mfma_f32_16x16x32_bf16 v[108:111], v[148:151], v[224:227], v[108:111]
    v_rcp_f32 v9, v9
    buffer_load_dwordx4 v[204:207], v5, s[12:15], s40 offen offset:1024 sc1
    s_waitcnt vmcnt(21)
    v_mfma_f32_16x16x32_bf16 v[112:115], v[152:155], v[212:215], v[112:115]
    s_nop 0
    v_mfma_f32_16x16x32_bf16 v[116:119], v[152:155], v[216:219], v[116:119]
    v_mul_f32 v0, v0, v8
    v_mfma_f32_16x16x32_bf16 v[120:123], v[152:155], v[220:223], v[120:123]
    v_mul_f32 v1, v1, v9
    v_mfma_f32_16x16x32_bf16 v[124:127], v[152:155], v[224:227], v[124:127]
    v_cvt_pk_bf16_f32 v247, v0, v1
    buffer_load_dwordx4 v[208:211], v5, s[12:15], s69 offen offset:2048 sc1
    s_waitcnt vmcnt(8)
    ds_read_b128 v[212:215], v12 offset:0
    ds_read_b128 v[216:219], v12 offset:2048
    ds_read_b128 v[220:223], v12 offset:4096
    ds_read_b128 v[224:227], v12 offset:6144
    s_waitcnt lgkmcnt(4)
    s_mov_b32 s41, 5
    s_lshl_b32 s41, s41, 9
    s_mov_b32 s40, 4
    s_mul_i32 s40, s40, 458752
    s_add_u32 s40, s40, s38
    s_add_u32 s40, s40, 57344
    s_sub_u32 s69, s40, s68
    s_waitcnt vmcnt(20)
    v_mfma_f32_16x16x32_bf16 v[16:19], v[156:159], v[228:231], v[16:19]
    v_lshlrev_b32 v0, 16, v248
    v_and_b32 v1, s49, v248
    v_mfma_f32_16x16x32_bf16 v[20:23], v[156:159], v[232:235], v[20:23]
    v_fmaak_f32 v8, v0, v0, 0x41b2e92f
    v_fmaak_f32 v9, v1, v1, 0x41b2e92f
    s_add_u32 m0, s60, 8192
    s_add_u32 s42, s41, s62
    buffer_load_dwordx4 v6, s[8:11], s42 offen  lds
    v_mfma_f32_16x16x32_bf16 v[24:27], v[156:159], v[236:239], v[24:27]
    v_mul_f32 v8, v8, v0
    v_mul_f32 v9, v9, v1
    v_mfma_f32_16x16x32_bf16 v[28:31], v[156:159], v[240:243], v[28:31]
    v_mul_f32 v8, 0xbdd2d3e8, v8
    v_mul_f32 v9, 0xbdd2d3e8, v9
    buffer_load_dwordx4 v[128:131], v4, s[12:15], s40 offen offset:0 sc1
    s_waitcnt vmcnt(20)
    v_mfma_f32_16x16x32_bf16 v[32:35], v[160:163], v[228:231], v[32:35]
    v_exp_f32 v8, v8
    v_exp_f32 v9, v9
    v_mfma_f32_16x16x32_bf16 v[36:39], v[160:163], v[232:235], v[36:39]
    s_nop 0
    v_add_f32 v8, 1.0, v8
    s_add_u32 m0, s60, 9216
    s_nop 0
    buffer_load_dwordx4 v7, s[8:11], s42 offen  lds
    v_mfma_f32_16x16x32_bf16 v[40:43], v[160:163], v[236:239], v[40:43]
    v_add_f32 v9, 1.0, v9
    v_rcp_f32 v8, v8
    v_mfma_f32_16x16x32_bf16 v[44:47], v[160:163], v[240:243], v[44:47]
    v_rcp_f32 v9, v9
    s_nop 0
    buffer_load_dwordx4 v[132:135], v4, s[12:15], s40 offen offset:1024 sc1
    s_waitcnt vmcnt(20)
    v_mfma_f32_16x16x32_bf16 v[48:51], v[164:167], v[228:231], v[48:51]
    v_mul_f32 v0, v0, v8
    v_mul_f32 v1, v1, v9
    v_mfma_f32_16x16x32_bf16 v[52:55], v[164:167], v[232:235], v[52:55]
    v_cvt_pk_bf16_f32 v248, v0, v1
    v_lshlrev_b32 v0, 16, v249
    s_add_u32 m0, s60, 10240
    s_add_u32 s42, s41, s63
    buffer_load_dwordx4 v6, s[8:11], s42 offen  lds
    v_mfma_f32_16x16x32_bf16 v[56:59], v[164:167], v[236:239], v[56:59]
    v_and_b32 v1, s49, v249
    v_mfma_f32_16x16x32_bf16 v[60:63], v[164:167], v[240:243], v[60:63]
    v_fmaak_f32 v8, v0, v0, 0x41b2e92f
    buffer_load_dwordx4 v[136:139], v4, s[12:15], s40 offen offset:2048 sc1
    s_waitcnt vmcnt(20)
    v_mfma_f32_16x16x32_bf16 v[64:67], v[168:171], v[228:231], v[64:67]
    v_fmaak_f32 v9, v1, v1, 0x41b2e92f
    v_mfma_f32_16x16x32_bf16 v[68:71], v[168:171], v[232:235], v[68:71]
    v_mul_f32 v8, v8, v0
    s_add_u32 m0, s60, 11264
    s_nop 0
    buffer_load_dwordx4 v7, s[8:11], s42 offen  lds
    v_mfma_f32_16x16x32_bf16 v[72:75], v[168:171], v[236:239], v[72:75]
    v_mul_f32 v9, v9, v1
    v_mfma_f32_16x16x32_bf16 v[76:79], v[168:171], v[240:243], v[76:79]
    v_mul_f32 v8, 0xbdd2d3e8, v8
    buffer_load_dwordx4 v[140:143], v4, s[12:15], s40 offen offset:3072 sc1
    s_waitcnt vmcnt(20)
    v_mfma_f32_16x16x32_bf16 v[80:83], v[172:175], v[228:231], v[80:83]
    v_mul_f32 v9, 0xbdd2d3e8, v9
    v_mfma_f32_16x16x32_bf16 v[84:87], v[172:175], v[232:235], v[84:87]
    v_exp_f32 v8, v8
    s_add_u32 m0, s60, 12288
    s_add_u32 s42, s41, s64
    buffer_load_dwordx4 v6, s[8:11], s42 offen  lds
    v_mfma_f32_16x16x32_bf16 v[88:91], v[172:175], v[236:239], v[88:91]
    v_exp_f32 v9, v9
    v_mfma_f32_16x16x32_bf16 v[92:95], v[172:175], v[240:243], v[92:95]
    s_nop 0
    buffer_load_dwordx4 v[144:147], v5, s[12:15], s40 offen offset:0 sc1
    s_waitcnt vmcnt(20)
    v_mfma_f32_16x16x32_bf16 v[96:99], v[176:179], v[228:231], v[96:99]
    v_add_f32 v8, 1.0, v8
    v_mfma_f32_16x16x32_bf16 v[100:103], v[176:179], v[232:235], v[100:103]
    v_add_f32 v9, 1.0, v9
    s_add_u32 m0, s60, 13312
    s_nop 0
    buffer_load_dwordx4 v7, s[8:11], s42 offen  lds
    v_mfma_f32_16x16x32_bf16 v[104:107], v[176:179], v[236:239], v[104:107]
    v_rcp_f32 v8, v8
    v_mfma_f32_16x16x32_bf16 v[108:111], v[176:179], v[240:243], v[108:111]
    v_rcp_f32 v9, v9
    buffer_load_dwordx4 v[148:151], v5, s[12:15], s40 offen offset:1024 sc1
    s_waitcnt vmcnt(19)
    v_mfma_f32_16x16x32_bf16 v[112:115], v[180:183], v[228:231], v[112:115]
    s_nop 0
    v_mfma_f32_16x16x32_bf16 v[116:119], v[180:183], v[232:235], v[116:119]
    v_mul_f32 v0, v0, v8
    s_add_u32 m0, s60, 14336
    s_add_u32 s42, s41, s65
    buffer_load_dwordx4 v6, s[8:11], s42 offen  lds
    v_mfma_f32_16x16x32_bf16 v[120:123], v[180:183], v[236:239], v[120:123]
    v_mul_f32 v1, v1, v9
    v_mfma_f32_16x16x32_bf16 v[124:127], v[180:183], v[240:243], v[124:127]
    v_cvt_pk_bf16_f32 v249, v0, v1
    s_add_u32 m0, s60, 15360
    s_nop 0
    buffer_load_dwordx4 v7, s[8:11], s42 offen  lds
    buffer_load_dwordx4 v[152:155], v5, s[12:15], s69 offen offset:2048 sc1
    ds_read_b128 v[228:231], v13 offset:0
    ds_read_b128 v[232:235], v13 offset:2048
    ds_read_b128 v[236:239], v13 offset:4096
    ds_read_b128 v[240:243], v13 offset:6144
    s_waitcnt lgkmcnt(4)
    s_mov_b32 s40, 5
    s_mul_i32 s40, s40, 458752
    s_add_u32 s40, s40, s38
    s_sub_u32 s69, s40, s68
    s_waitcnt vmcnt(21)
    v_mfma_f32_16x16x32_bf16 v[16:19], v[184:187], v[212:215], v[16:19]
    v_lshlrev_b32 v0, 16, v250
    v_mfma_f32_16x16x32_bf16 v[20:23], v[184:187], v[216:219], v[20:23]
    v_and_b32 v1, s49, v250
    v_mfma_f32_16x16x32_bf16 v[24:27], v[184:187], v[220:223], v[24:27]
    v_fmaak_f32 v8, v0, v0, 0x41b2e92f
    v_mfma_f32_16x16x32_bf16 v[28:31], v[184:187], v[224:227], v[28:31]
    v_fmaak_f32 v9, v1, v1, 0x41b2e92f
    buffer_load_dwordx4 v[156:159], v4, s[12:15], s40 offen offset:0 sc1
    s_waitcnt vmcnt(21)
    v_mfma_f32_16x16x32_bf16 v[32:35], v[188:191], v[212:215], v[32:35]
    v_mul_f32 v8, v8, v0
    v_mfma_f32_16x16x32_bf16 v[36:39], v[188:191], v[216:219], v[36:39]
    v_mul_f32 v9, v9, v1
    v_mfma_f32_16x16x32_bf16 v[40:43], v[188:191], v[220:223], v[40:43]
    v_mul_f32 v8, 0xbdd2d3e8, v8
    v_mfma_f32_16x16x32_bf16 v[44:47], v[188:191], v[224:227], v[44:47]
    v_mul_f32 v9, 0xbdd2d3e8, v9
    buffer_load_dwordx4 v[160:163], v4, s[12:15], s40 offen offset:1024 sc1
    s_waitcnt vmcnt(21)
    v_mfma_f32_16x16x32_bf16 v[48:51], v[192:195], v[212:215], v[48:51]
    v_exp_f32 v8, v8
    v_mfma_f32_16x16x32_bf16 v[52:55], v[192:195], v[216:219], v[52:55]
    v_exp_f32 v9, v9
    v_mfma_f32_16x16x32_bf16 v[56:59], v[192:195], v[220:223], v[56:59]
    s_nop 0
    v_mfma_f32_16x16x32_bf16 v[60:63], v[192:195], v[224:227], v[60:63]
    v_add_f32 v8, 1.0, v8
    buffer_load_dwordx4 v[164:167], v4, s[12:15], s40 offen offset:2048 sc1
    s_waitcnt vmcnt(21)
    v_mfma_f32_16x16x32_bf16 v[64:67], v[196:199], v[212:215], v[64:67]
    v_add_f32 v9, 1.0, v9
    v_mfma_f32_16x16x32_bf16 v[68:71], v[196:199], v[216:219], v[68:71]
    v_rcp_f32 v8, v8
    v_mfma_f32_16x16x32_bf16 v[72:75], v[196:199], v[220:223], v[72:75]
    v_rcp_f32 v9, v9
    v_mfma_f32_16x16x32_bf16 v[76:79], v[196:199], v[224:227], v[76:79]
    s_nop 0
    buffer_load_dwordx4 v[168:171], v4, s[12:15], s40 offen offset:3072 sc1
    s_waitcnt vmcnt(21)
    v_mfma_f32_16x16x32_bf16 v[80:83], v[200:203], v[212:215], v[80:83]
    v_mul_f32 v0, v0, v8
    v_mfma_f32_16x16x32_bf16 v[84:87], v[200:203], v[216:219], v[84:87]
    v_mul_f32 v1, v1, v9
    v_mfma_f32_16x16x32_bf16 v[88:91], v[200:203], v[220:223], v[88:91]
    v_cvt_pk_bf16_f32 v250, v0, v1
    v_mfma_f32_16x16x32_bf16 v[92:95], v[200:203], v[224:227], v[92:95]
    buffer_load_dwordx4 v[172:175], v5, s[12:15], s40 offen offset:0 sc1
    s_waitcnt vmcnt(21)
    v_mfma_f32_16x16x32_bf16 v[96:99], v[204:207], v[212:215], v[96:99]
    v_mfma_f32_16x16x32_bf16 v[100:103], v[204:207], v[216:219], v[100:103]
    v_mfma_f32_16x16x32_bf16 v[104:107], v[204:207], v[220:223], v[104:107]
    v_mfma_f32_16x16x32_bf16 v[108:111], v[204:207], v[224:227], v[108:111]
    buffer_load_dwordx4 v[176:179], v5, s[12:15], s40 offen offset:1024 sc1
    s_waitcnt vmcnt(21)
    v_mfma_f32_16x16x32_bf16 v[112:115], v[208:211], v[212:215], v[112:115]
    v_mfma_f32_16x16x32_bf16 v[116:119], v[208:211], v[216:219], v[116:119]
    v_mfma_f32_16x16x32_bf16 v[120:123], v[208:211], v[220:223], v[120:123]
    v_mfma_f32_16x16x32_bf16 v[124:127], v[208:211], v[224:227], v[124:127]
    buffer_load_dwordx4 v[180:183], v5, s[12:15], s69 offen offset:2048 sc1
    s_waitcnt vmcnt(8)
    ds_read_b128 v[212:215], v12 offset:8192
    ds_read_b128 v[216:219], v12 offset:10240
    ds_read_b128 v[220:223], v12 offset:12288
    ds_read_b128 v[224:227], v12 offset:14336
    s_waitcnt lgkmcnt(4)
    s_mov_b32 s41, 6
    s_lshl_b32 s41, s41, 9
    s_mov_b32 s40, 5
    s_mul_i32 s40, s40, 458752
    s_add_u32 s40, s40, s38
    s_add_u32 s40, s40, 57344
    s_sub_u32 s69, s40, s68
    s_waitcnt vmcnt(20)
    v_mfma_f32_16x16x32_bf16 v[16:19], v[128:131], v[228:231], v[16:19]
    v_lshlrev_b32 v0, 16, v251
    v_mfma_f32_16x16x32_bf16 v[20:23], v[128:131], v[232:235], v[20:23]
    v_and_b32 v1, s49, v251
    s_add_u32 m0, s60, 0
    s_add_u32 s42, s41, s62
    buffer_load_dwordx4 v6, s[8:11], s42 offen  lds
    v_mfma_f32_16x16x32_bf16 v[24:27], v[128:131], v[236:239], v[24:27]
    v_fmaak_f32 v8, v0, v0, 0x41b2e92f
    v_mfma_f32_16x16x32_bf16 v[28:31], v[128:131], v[240:243], v[28:31]
    v_fmaak_f32 v9, v1, v1, 0x41b2e92f
    buffer_load_dwordx4 v[184:187], v4, s[12:15], s40 offen offset:0 sc1
    s_waitcnt vmcnt(20)
    v_mfma_f32_16x16x32_bf16 v[32:35], v[132:135], v[228:231], v[32:35]
    v_mul_f32 v8, v8, v0
    v_mfma_f32_16x16x32_bf16 v[36:39], v[132:135], v[232:235], v[36:39]
    v_mul_f32 v9, v9, v1
    s_add_u32 m0, s60, 1024
    s_nop 0
    buffer_load_dwordx4 v7, s[8:11], s42 offen  lds
    v_mfma_f32_16x16x32_bf16 v[40:43], v[132:135], v[236:239], v[40:43]
    v_mul_f32 v8, 0xbdd2d3e8, v8
    v_mfma_f32_16x16x32_bf16 v[44:47], v[132:135], v[240:243], v[44:47]
    v_mul_f32 v9, 0xbdd2d3e8, v9
    buffer_load_dwordx4 v[188:191], v4, s[12:15], s40 offen offset:1024 sc1
    s_waitcnt vmcnt(20)
    v_mfma_f32_16x16x32_bf16 v[48:51], v[136:139], v[228:231], v[48:51]
    v_exp_f32 v8, v8
    v_mfma_f32_16x16x32_bf16 v[52:55], v[136:139], v[232:235], v[52:55]
    v_exp_f32 v9, v9
    s_add_u32 m0, s60, 2048
    s_add_u32 s42, s41, s63
    buffer_load_dwordx4 v6, s[8:11], s42 offen  lds
    v_mfma_f32_16x16x32_bf16 v[56:59], v[136:139], v[236:239], v[56:59]
    s_nop 0
    v_mfma_f32_16x16x32_bf16 v[60:63], v[136:139], v[240:243], v[60:63]
    v_add_f32 v8, 1.0, v8
    buffer_load_dwordx4 v[192:195], v4, s[12:15], s40 offen offset:2048 sc1
    s_waitcnt vmcnt(20)
    v_mfma_f32_16x16x32_bf16 v[64:67], v[140:143], v[228:231], v[64:67]
    v_add_f32 v9, 1.0, v9
    v_mfma_f32_16x16x32_bf16 v[68:71], v[140:143], v[232:235], v[68:71]
    v_rcp_f32 v8, v8
    s_add_u32 m0, s60, 3072
    s_nop 0
    buffer_load_dwordx4 v7, s[8:11], s42 offen  lds
    v_mfma_f32_16x16x32_bf16 v[72:75], v[140:143], v[236:239], v[72:75]
    v_rcp_f32 v9, v9
    v_mfma_f32_16x16x32_bf16 v[76:79], v[140:143], v[240:243], v[76:79]
    s_nop 0
    buffer_load_dwordx4 v[196:199], v4, s[12:15], s40 offen offset:3072 sc1
    s_waitcnt vmcnt(20)
    v_mfma_f32_16x16x32_bf16 v[80:83], v[144:147], v[228:231], v[80:83]
    v_mul_f32 v0, v0, v8
    v_mfma_f32_16x16x32_bf16 v[84:87], v[144:147], v[232:235], v[84:87]
    v_mul_f32 v1, v1, v9
    s_add_u32 m0, s60, 4096
    s_add_u32 s42, s41, s64
    buffer_load_dwordx4 v6, s[8:11], s42 offen  lds
    v_mfma_f32_16x16x32_bf16 v[88:91], v[144:147], v[236:239], v[88:91]
    v_cvt_pk_bf16_f32 v251, v0, v1
    v_mfma_f32_16x16x32_bf16 v[92:95], v[144:147], v[240:243], v[92:95]
    buffer_load_dwordx4 v[200:203], v5, s[12:15], s40 offen offset:0 sc1
    s_waitcnt vmcnt(20)
    v_mfma_f32_16x16x32_bf16 v[96:99], v[148:151], v[228:231], v[96:99]
    v_mfma_f32_16x16x32_bf16 v[100:103], v[148:151], v[232:235], v[100:103]
    s_add_u32 m0, s60, 5120
    s_nop 0
    buffer_load_dwordx4 v7, s[8:11], s42 offen  lds
    v_mfma_f32_16x16x32_bf16 v[104:107], v[148:151], v[236:239], v[104:107]
    v_mfma_f32_16x16x32_bf16 v[108:111], v[148:151], v[240:243], v[108:111]
    buffer_load_dwordx4 v[204:207], v5, s[12:15], s40 offen offset:1024 sc1
    s_waitcnt vmcnt(19)
    v_mfma_f32_16x16x32_bf16 v[112:115], v[152:155], v[228:231], v[112:115]
    v_mfma_f32_16x16x32_bf16 v[116:119], v[152:155], v[232:235], v[116:119]
    s_add_u32 m0, s60, 6144
    s_add_u32 s42, s41, s65
    buffer_load_dwordx4 v6, s[8:11], s42 offen  lds
    v_mfma_f32_16x16x32_bf16 v[120:123], v[152:155], v[236:239], v[120:123]
    v_mfma_f32_16x16x32_bf16 v[124:127], v[152:155], v[240:243], v[124:127]
    s_add_u32 m0, s60, 7168
    s_nop 0
    buffer_load_dwordx4 v7, s[8:11], s42 offen  lds
    buffer_load_dwordx4 v[208:211], v5, s[12:15], s69 offen offset:2048 sc1
    ds_read_b128 v[228:231], v13 offset:8192
    ds_read_b128 v[232:235], v13 offset:10240
    ds_read_b128 v[236:239], v13 offset:12288
    ds_read_b128 v[240:243], v13 offset:14336
    s_waitcnt lgkmcnt(4)
    s_mov_b32 s40, 6
    s_mul_i32 s40, s40, 458752
    s_add_u32 s40, s40, s38
    s_sub_u32 s69, s40, s68
    s_waitcnt vmcnt(21)
    v_mfma_f32_16x16x32_bf16 v[16:19], v[156:159], v[212:215], v[16:19]
    v_lshlrev_b32 v0, 16, v252
    v_mfma_f32_16x16x32_bf16 v[20:23], v[156:159], v[216:219], v[20:23]
    v_and_b32 v1, s49, v252
    v_mfma_f32_16x16x32_bf16 v[24:27], v[156:159], v[220:223], v[24:27]
    v_fmaak_f32 v8, v0, v0, 0x41b2e92f
    v_mfma_f32_16x16x32_bf16 v[28:31], v[156:159], v[224:227], v[28:31]
    v_fmaak_f32 v9, v1, v1, 0x41b2e92f
    buffer_load_dwordx4 v[128:131], v4, s[12:15], s40 offen offset:0 sc1
    s_waitcnt vmcnt(21)
    v_mfma_f32_16x16x32_bf16 v[32:35], v[160:163], v[212:215], v[32:35]
    v_mul_f32 v8, v8, v0
    v_mfma_f32_16x16x32_bf16 v[36:39], v[160:163], v[216:219], v[36:39]
    v_mul_f32 v9, v9, v1
    v_mfma_f32_16x16x32_bf16 v[40:43], v[160:163], v[220:223], v[40:43]
    v_mul_f32 v8, 0xbdd2d3e8, v8
    v_mfma_f32_16x16x32_bf16 v[44:47], v[160:163], v[224:227], v[44:47]
    v_mul_f32 v9, 0xbdd2d3e8, v9
    buffer_load_dwordx4 v[132:135], v4, s[12:15], s40 offen offset:1024 sc1
    s_waitcnt vmcnt(21)
    v_mfma_f32_16x16x32_bf16 v[48:51], v[164:167], v[212:215], v[48:51]
    v_exp_f32 v8, v8
    v_mfma_f32_16x16x32_bf16 v[52:55], v[164:167], v[216:219], v[52:55]
    v_exp_f32 v9, v9
    v_mfma_f32_16x16x32_bf16 v[56:59], v[164:167], v[220:223], v[56:59]
    s_nop 0
    v_mfma_f32_16x16x32_bf16 v[60:63], v[164:167], v[224:227], v[60:63]
    v_add_f32 v8, 1.0, v8
    buffer_load_dwordx4 v[136:139], v4, s[12:15], s40 offen offset:2048 sc1
    s_waitcnt vmcnt(21)
    v_mfma_f32_16x16x32_bf16 v[64:67], v[168:171], v[212:215], v[64:67]
    v_add_f32 v9, 1.0, v9
    v_mfma_f32_16x16x32_bf16 v[68:71], v[168:171], v[216:219], v[68:71]
    v_rcp_f32 v8, v8
    v_mfma_f32_16x16x32_bf16 v[72:75], v[168:171], v[220:223], v[72:75]
    v_rcp_f32 v9, v9
    v_mfma_f32_16x16x32_bf16 v[76:79], v[168:171], v[224:227], v[76:79]
    s_nop 0
    buffer_load_dwordx4 v[140:143], v4, s[12:15], s40 offen offset:3072 sc1
    s_waitcnt vmcnt(21)
    v_mfma_f32_16x16x32_bf16 v[80:83], v[172:175], v[212:215], v[80:83]
    v_mul_f32 v0, v0, v8
    v_mfma_f32_16x16x32_bf16 v[84:87], v[172:175], v[216:219], v[84:87]
    v_mul_f32 v1, v1, v9
    v_mfma_f32_16x16x32_bf16 v[88:91], v[172:175], v[220:223], v[88:91]
    v_cvt_pk_bf16_f32 v252, v0, v1
    v_mfma_f32_16x16x32_bf16 v[92:95], v[172:175], v[224:227], v[92:95]
    buffer_load_dwordx4 v[144:147], v5, s[12:15], s40 offen offset:0 sc1
    s_waitcnt vmcnt(21)
    v_mfma_f32_16x16x32_bf16 v[96:99], v[176:179], v[212:215], v[96:99]
    v_mfma_f32_16x16x32_bf16 v[100:103], v[176:179], v[216:219], v[100:103]
    v_mfma_f32_16x16x32_bf16 v[104:107], v[176:179], v[220:223], v[104:107]
    v_mfma_f32_16x16x32_bf16 v[108:111], v[176:179], v[224:227], v[108:111]
    buffer_load_dwordx4 v[148:151], v5, s[12:15], s40 offen offset:1024 sc1
    s_waitcnt vmcnt(21)
    v_mfma_f32_16x16x32_bf16 v[112:115], v[180:183], v[212:215], v[112:115]
    v_mfma_f32_16x16x32_bf16 v[116:119], v[180:183], v[216:219], v[116:119]
    v_mfma_f32_16x16x32_bf16 v[120:123], v[180:183], v[220:223], v[120:123]
    v_mfma_f32_16x16x32_bf16 v[124:127], v[180:183], v[224:227], v[124:127]
    buffer_load_dwordx4 v[152:155], v5, s[12:15], s69 offen offset:2048 sc1
    s_waitcnt vmcnt(8)
    ds_read_b128 v[212:215], v12 offset:0
    ds_read_b128 v[216:219], v12 offset:2048
    ds_read_b128 v[220:223], v12 offset:4096
    ds_read_b128 v[224:227], v12 offset:6144
    s_waitcnt lgkmcnt(4)
    s_mov_b32 s41, 7
    s_lshl_b32 s41, s41, 9
    s_mov_b32 s40, 6
    s_mul_i32 s40, s40, 458752
    s_add_u32 s40, s40, s38
    s_add_u32 s40, s40, 57344
    s_sub_u32 s69, s40, s68
    s_waitcnt vmcnt(20)
    v_mfma_f32_16x16x32_bf16 v[16:19], v[184:187], v[228:231], v[16:19]
    v_lshlrev_b32 v0, 16, v253
    v_mfma_f32_16x16x32_bf16 v[20:23], v[184:187], v[232:235], v[20:23]
    v_and_b32 v1, s49, v253
    s_add_u32 m0, s60, 8192
    s_add_u32 s42, s41, s62
    buffer_load_dwordx4 v6, s[8:11], s42 offen  lds
    v_mfma_f32_16x16x32_bf16 v[24:27], v[184:187], v[236:239], v[24:27]
    v_fmaak_f32 v8, v0, v0, 0x41b2e92f
    v_mfma_f32_16x16x32_bf16 v[28:31], v[184:187], v[240:243], v[28:31]
    v_fmaak_f32 v9, v1, v1, 0x41b2e92f
    buffer_load_dwordx4 v[156:159], v4, s[12:15], s40 offen offset:0 sc1
    s_waitcnt vmcnt(20)
    v_mfma_f32_16x16x32_bf16 v[32:35], v[188:191], v[228:231], v[32:35]
    v_mul_f32 v8, v8, v0
    v_mfma_f32_16x16x32_bf16 v[36:39], v[188:191], v[232:235], v[36:39]
    v_mul_f32 v9, v9, v1
    s_add_u32 m0, s60, 9216
    s_nop 0
    buffer_load_dwordx4 v7, s[8:11], s42 offen  lds
    v_mfma_f32_16x16x32_bf16 v[40:43], v[188:191], v[236:239], v[40:43]
    v_mul_f32 v8, 0xbdd2d3e8, v8
    v_mfma_f32_16x16x32_bf16 v[44:47], v[188:191], v[240:243], v[44:47]
    v_mul_f32 v9, 0xbdd2d3e8, v9
    buffer_load_dwordx4 v[160:163], v4, s[12:15], s40 offen offset:1024 sc1
    s_waitcnt vmcnt(20)
    v_mfma_f32_16x16x32_bf16 v[48:51], v[192:195], v[228:231], v[48:51]
    v_exp_f32 v8, v8
    v_mfma_f32_16x16x32_bf16 v[52:55], v[192:195], v[232:235], v[52:55]
    v_exp_f32 v9, v9
    s_add_u32 m0, s60, 10240
    s_add_u32 s42, s41, s63
    buffer_load_dwordx4 v6, s[8:11], s42 offen  lds
    v_mfma_f32_16x16x32_bf16 v[56:59], v[192:195], v[236:239], v[56:59]
    s_nop 0
    v_mfma_f32_16x16x32_bf16 v[60:63], v[192:195], v[240:243], v[60:63]
    v_add_f32 v8, 1.0, v8
    buffer_load_dwordx4 v[164:167], v4, s[12:15], s40 offen offset:2048 sc1
    s_waitcnt vmcnt(20)
    v_mfma_f32_16x16x32_bf16 v[64:67], v[196:199], v[228:231], v[64:67]
    v_add_f32 v9, 1.0, v9
    v_mfma_f32_16x16x32_bf16 v[68:71], v[196:199], v[232:235], v[68:71]
    v_rcp_f32 v8, v8
    s_add_u32 m0, s60, 11264
    s_nop 0
    buffer_load_dwordx4 v7, s[8:11], s42 offen  lds
    v_mfma_f32_16x16x32_bf16 v[72:75], v[196:199], v[236:239], v[72:75]
    v_rcp_f32 v9, v9
    v_mfma_f32_16x16x32_bf16 v[76:79], v[196:199], v[240:243], v[76:79]
    s_nop 0
    buffer_load_dwordx4 v[168:171], v4, s[12:15], s40 offen offset:3072 sc1
    s_waitcnt vmcnt(20)
    v_mfma_f32_16x16x32_bf16 v[80:83], v[200:203], v[228:231], v[80:83]
    v_mul_f32 v0, v0, v8
    v_mfma_f32_16x16x32_bf16 v[84:87], v[200:203], v[232:235], v[84:87]
    v_mul_f32 v1, v1, v9
    s_add_u32 m0, s60, 12288
    s_add_u32 s42, s41, s64
    buffer_load_dwordx4 v6, s[8:11], s42 offen  lds
    v_mfma_f32_16x16x32_bf16 v[88:91], v[200:203], v[236:239], v[88:91]
    v_cvt_pk_bf16_f32 v253, v0, v1
    v_mfma_f32_16x16x32_bf16 v[92:95], v[200:203], v[240:243], v[92:95]
    buffer_load_dwordx4 v[172:175], v5, s[12:15], s40 offen offset:0 sc1
    s_waitcnt vmcnt(20)
    v_mfma_f32_16x16x32_bf16 v[96:99], v[204:207], v[228:231], v[96:99]
    v_mfma_f32_16x16x32_bf16 v[100:103], v[204:207], v[232:235], v[100:103]
    s_add_u32 m0, s60, 13312
    s_nop 0
    buffer_load_dwordx4 v7, s[8:11], s42 offen  lds
    v_mfma_f32_16x16x32_bf16 v[104:107], v[204:207], v[236:239], v[104:107]
    v_mfma_f32_16x16x32_bf16 v[108:111], v[204:207], v[240:243], v[108:111]
    buffer_load_dwordx4 v[176:179], v5, s[12:15], s40 offen offset:1024 sc1
    s_waitcnt vmcnt(19)
    v_mfma_f32_16x16x32_bf16 v[112:115], v[208:211], v[228:231], v[112:115]
    v_mfma_f32_16x16x32_bf16 v[116:119], v[208:211], v[232:235], v[116:119]
    s_add_u32 m0, s60, 14336
    s_add_u32 s42, s41, s65
    buffer_load_dwordx4 v6, s[8:11], s42 offen  lds
    v_mfma_f32_16x16x32_bf16 v[120:123], v[208:211], v[236:239], v[120:123]
    v_mfma_f32_16x16x32_bf16 v[124:127], v[208:211], v[240:243], v[124:127]
    s_add_u32 m0, s60, 15360
    s_nop 0
    buffer_load_dwordx4 v7, s[8:11], s42 offen  lds
    buffer_load_dwordx4 v[180:183], v5, s[12:15], s69 offen offset:2048 sc1
    ds_read_b128 v[228:231], v13 offset:0
    ds_read_b128 v[232:235], v13 offset:2048
    ds_read_b128 v[236:239], v13 offset:4096
    ds_read_b128 v[240:243], v13 offset:6144
    s_waitcnt lgkmcnt(4)
    s_mov_b32 s40, 7
    s_mul_i32 s40, s40, 458752
    s_add_u32 s40, s40, s38
    s_sub_u32 s69, s40, s68
    s_waitcnt vmcnt(21)
    v_mfma_f32_16x16x32_bf16 v[16:19], v[128:131], v[212:215], v[16:19]
    v_lshlrev_b32 v0, 16, v254
    v_mfma_f32_16x16x32_bf16 v[20:23], v[128:131], v[216:219], v[20:23]
    v_and_b32 v1, s49, v254
    v_mfma_f32_16x16x32_bf16 v[24:27], v[128:131], v[220:223], v[24:27]
    v_fmaak_f32 v8, v0, v0, 0x41b2e92f
    v_mfma_f32_16x16x32_bf16 v[28:31], v[128:131], v[224:227], v[28:31]
    v_fmaak_f32 v9, v1, v1, 0x41b2e92f
    buffer_load_dwordx4 v[184:187], v4, s[12:15], s40 offen offset:0 sc1
    s_waitcnt vmcnt(21)
    v_mfma_f32_16x16x32_bf16 v[32:35], v[132:135], v[212:215], v[32:35]
    v_mul_f32 v8, v8, v0
    v_mfma_f32_16x16x32_bf16 v[36:39], v[132:135], v[216:219], v[36:39]
    v_mul_f32 v9, v9, v1
    v_mfma_f32_16x16x32_bf16 v[40:43], v[132:135], v[220:223], v[40:43]
    v_mul_f32 v8, 0xbdd2d3e8, v8
    v_mfma_f32_16x16x32_bf16 v[44:47], v[132:135], v[224:227], v[44:47]
    v_mul_f32 v9, 0xbdd2d3e8, v9
    buffer_load_dwordx4 v[188:191], v4, s[12:15], s40 offen offset:1024 sc1
    s_waitcnt vmcnt(21)
    v_mfma_f32_16x16x32_bf16 v[48:51], v[136:139], v[212:215], v[48:51]
    v_exp_f32 v8, v8
    v_mfma_f32_16x16x32_bf16 v[52:55], v[136:139], v[216:219], v[52:55]
    v_exp_f32 v9, v9
    v_mfma_f32_16x16x32_bf16 v[56:59], v[136:139], v[220:223], v[56:59]
    s_nop 0
    v_mfma_f32_16x16x32_bf16 v[60:63], v[136:139], v[224:227], v[60:63]
    v_add_f32 v8, 1.0, v8
    buffer_load_dwordx4 v[192:195], v4, s[12:15], s40 offen offset:2048 sc1
    s_waitcnt vmcnt(21)
    v_mfma_f32_16x16x32_bf16 v[64:67], v[140:143], v[212:215], v[64:67]
    v_add_f32 v9, 1.0, v9
    v_mfma_f32_16x16x32_bf16 v[68:71], v[140:143], v[216:219], v[68:71]
    v_rcp_f32 v8, v8
    v_mfma_f32_16x16x32_bf16 v[72:75], v[140:143], v[220:223], v[72:75]
    v_rcp_f32 v9, v9
    v_mfma_f32_16x16x32_bf16 v[76:79], v[140:143], v[224:227], v[76:79]
    s_nop 0
    buffer_load_dwordx4 v[196:199], v4, s[12:15], s40 offen offset:3072 sc1
    s_waitcnt vmcnt(21)
    v_mfma_f32_16x16x32_bf16 v[80:83], v[144:147], v[212:215], v[80:83]
    v_mul_f32 v0, v0, v8
    v_mfma_f32_16x16x32_bf16 v[84:87], v[144:147], v[216:219], v[84:87]
    v_mul_f32 v1, v1, v9
    v_mfma_f32_16x16x32_bf16 v[88:91], v[144:147], v[220:223], v[88:91]
    v_cvt_pk_bf16_f32 v254, v0, v1
    v_mfma_f32_16x16x32_bf16 v[92:95], v[144:147], v[224:227], v[92:95]
    buffer_load_dwordx4 v[200:203], v5, s[12:15], s40 offen offset:0 sc1
    s_waitcnt vmcnt(21)
    v_mfma_f32_16x16x32_bf16 v[96:99], v[148:151], v[212:215], v[96:99]
    v_mfma_f32_16x16x32_bf16 v[100:103], v[148:151], v[216:219], v[100:103]
    v_mfma_f32_16x16x32_bf16 v[104:107], v[148:151], v[220:223], v[104:107]
    v_mfma_f32_16x16x32_bf16 v[108:111], v[148:151], v[224:227], v[108:111]
    buffer_load_dwordx4 v[204:207], v5, s[12:15], s40 offen offset:1024 sc1
    s_waitcnt vmcnt(21)
    v_mfma_f32_16x16x32_bf16 v[112:115], v[152:155], v[212:215], v[112:115]
    v_mfma_f32_16x16x32_bf16 v[116:119], v[152:155], v[216:219], v[116:119]
    v_mfma_f32_16x16x32_bf16 v[120:123], v[152:155], v[220:223], v[120:123]
    v_mfma_f32_16x16x32_bf16 v[124:127], v[152:155], v[224:227], v[124:127]
    buffer_load_dwordx4 v[208:211], v5, s[12:15], s69 offen offset:2048 sc1
    s_waitcnt vmcnt(8)
    ds_read_b128 v[212:215], v12 offset:8192
    ds_read_b128 v[216:219], v12 offset:10240
    ds_read_b128 v[220:223], v12 offset:12288
    ds_read_b128 v[224:227], v12 offset:14336
    s_waitcnt lgkmcnt(4)
    s_mov_b32 s40, 7
    s_mul_i32 s40, s40, 458752
    s_add_u32 s40, s40, s38
    s_add_u32 s40, s40, 57344
    s_sub_u32 s69, s40, s68
    s_waitcnt vmcnt(20)
    v_mfma_f32_16x16x32_bf16 v[16:19], v[156:159], v[228:231], v[16:19]
    v_lshlrev_b32 v0, 16, v255
    v_mfma_f32_16x16x32_bf16 v[20:23], v[156:159], v[232:235], v[20:23]
    v_and_b32 v1, s49, v255
    v_mfma_f32_16x16x32_bf16 v[24:27], v[156:159], v[236:239], v[24:27]
    v_fmaak_f32 v8, v0, v0, 0x41b2e92f
    v_mfma_f32_16x16x32_bf16 v[28:31], v[156:159], v[240:243], v[28:31]
    v_fmaak_f32 v9, v1, v1, 0x41b2e92f
    buffer_load_dwordx4 v[128:131], v4, s[12:15], s40 offen offset:0 sc1
    s_waitcnt vmcnt(19)
    v_mfma_f32_16x16x32_bf16 v[32:35], v[160:163], v[228:231], v[32:35]
    v_mul_f32 v8, v8, v0
    v_mfma_f32_16x16x32_bf16 v[36:39], v[160:163], v[232:235], v[36:39]
    v_mul_f32 v9, v9, v1
    v_mfma_f32_16x16x32_bf16 v[40:43], v[160:163], v[236:239], v[40:43]
    v_mul_f32 v8, 0xbdd2d3e8, v8
    v_mfma_f32_16x16x32_bf16 v[44:47], v[160:163], v[240:243], v[44:47]
    v_mul_f32 v9, 0xbdd2d3e8, v9
    buffer_load_dwordx4 v[132:135], v4, s[12:15], s40 offen offset:1024 sc1
    s_waitcnt vmcnt(18)
    v_mfma_f32_16x16x32_bf16 v[48:51], v[164:167], v[228:231], v[48:51]
    v_exp_f32 v8, v8
    v_mfma_f32_16x16x32_bf16 v[52:55], v[164:167], v[232:235], v[52:55]
    v_exp_f32 v9, v9
    v_mfma_f32_16x16x32_bf16 v[56:59], v[164:167], v[236:239], v[56:59]
    s_nop 0
    v_mfma_f32_16x16x32_bf16 v[60:63], v[164:167], v[240:243], v[60:63]
    v_add_f32 v8, 1.0, v8
    buffer_load_dwordx4 v[136:139], v4, s[12:15], s40 offen offset:2048 sc1
    s_waitcnt vmcnt(17)
    v_mfma_f32_16x16x32_bf16 v[64:67], v[168:171], v[228:231], v[64:67]
    v_add_f32 v9, 1.0, v9
    v_mfma_f32_16x16x32_bf16 v[68:71], v[168:171], v[232:235], v[68:71]
    v_rcp_f32 v8, v8
    v_mfma_f32_16x16x32_bf16 v[72:75], v[168:171], v[236:239], v[72:75]
    v_rcp_f32 v9, v9
    v_mfma_f32_16x16x32_bf16 v[76:79], v[168:171], v[240:243], v[76:79]
    s_nop 0
    buffer_load_dwordx4 v[140:143], v4, s[12:15], s40 offen offset:3072 sc1
    s_waitcnt vmcnt(16)
    v_mfma_f32_16x16x32_bf16 v[80:83], v[172:175], v[228:231], v[80:83]
    v_mul_f32 v0, v0, v8
    v_mfma_f32_16x16x32_bf16 v[84:87], v[172:175], v[232:235], v[84:87]
    v_mul_f32 v1, v1, v9
    v_mfma_f32_16x16x32_bf16 v[88:91], v[172:175], v[236:239], v[88:91]
    v_cvt_pk_bf16_f32 v255, v0, v1
    v_mfma_f32_16x16x32_bf16 v[92:95], v[172:175], v[240:243], v[92:95]
    buffer_load_dwordx4 v[144:147], v5, s[12:15], s40 offen offset:0 sc1
    s_waitcnt vmcnt(15)
    v_mfma_f32_16x16x32_bf16 v[96:99], v[176:179], v[228:231], v[96:99]
    v_mfma_f32_16x16x32_bf16 v[100:103], v[176:179], v[232:235], v[100:103]
    v_mfma_f32_16x16x32_bf16 v[104:107], v[176:179], v[236:239], v[104:107]
    v_mfma_f32_16x16x32_bf16 v[108:111], v[176:179], v[240:243], v[108:111]
    buffer_load_dwordx4 v[148:151], v5, s[12:15], s40 offen offset:1024 sc1
    s_waitcnt vmcnt(13)
    v_mfma_f32_16x16x32_bf16 v[112:115], v[180:183], v[228:231], v[112:115]
    v_mfma_f32_16x16x32_bf16 v[116:119], v[180:183], v[232:235], v[116:119]
    v_mfma_f32_16x16x32_bf16 v[120:123], v[180:183], v[236:239], v[120:123]
    v_mfma_f32_16x16x32_bf16 v[124:127], v[180:183], v[240:243], v[124:127]
    buffer_load_dwordx4 v[152:155], v5, s[12:15], s69 offen offset:2048 sc1
    v_mov_b32 v10, 163328
    v_mov_b32 v2, 1
    s_mov_b64 exec, 1
    ds_add_u32 v10, v2 offset:40
    s_mov_b64 exec, -1
    s_waitcnt lgkmcnt(0)
    ds_read_b128 v[228:231], v13 offset:8192
    ds_read_b128 v[232:235], v13 offset:10240
    ds_read_b128 v[236:239], v13 offset:12288
    ds_read_b128 v[240:243], v13 offset:14336
    s_waitcnt lgkmcnt(4)
    s_waitcnt vmcnt(13)
    v_mfma_f32_16x16x32_bf16 v[16:19], v[184:187], v[212:215], v[16:19]
    v_lshlrev_b32 v0, 16, v14
    v_mfma_f32_16x16x32_bf16 v[20:23], v[184:187], v[216:219], v[20:23]
    v_and_b32 v1, s49, v14
    v_mfma_f32_16x16x32_bf16 v[24:27], v[184:187], v[220:223], v[24:27]
    v_fmaak_f32 v8, v0, v0, 0x41b2e92f
    v_mfma_f32_16x16x32_bf16 v[28:31], v[184:187], v[224:227], v[28:31]
    v_fmaak_f32 v9, v1, v1, 0x41b2e92f
    s_waitcnt vmcnt(12)
    v_mfma_f32_16x16x32_bf16 v[32:35], v[188:191], v[212:215], v[32:35]
    v_mul_f32 v8, v8, v0
    v_mfma_f32_16x16x32_bf16 v[36:39], v[188:191], v[216:219], v[36:39]
    v_mul_f32 v9, v9, v1
    v_mfma_f32_16x16x32_bf16 v[40:43], v[188:191], v[220:223], v[40:43]
    v_mul_f32 v8, 0xbdd2d3e8, v8
    v_mfma_f32_16x16x32_bf16 v[44:47], v[188:191], v[224:227], v[44:47]
    v_mul_f32 v9, 0xbdd2d3e8, v9
    s_waitcnt vmcnt(11)
    v_mfma_f32_16x16x32_bf16 v[48:51], v[192:195], v[212:215], v[48:51]
    v_exp_f32 v8, v8
    v_mfma_f32_16x16x32_bf16 v[52:55], v[192:195], v[216:219], v[52:55]
    v_exp_f32 v9, v9
    v_mfma_f32_16x16x32_bf16 v[56:59], v[192:195], v[220:223], v[56:59]
    s_nop 0
    v_mfma_f32_16x16x32_bf16 v[60:63], v[192:195], v[224:227], v[60:63]
    v_add_f32 v8, 1.0, v8
    s_waitcnt vmcnt(10)
    v_mfma_f32_16x16x32_bf16 v[64:67], v[196:199], v[212:215], v[64:67]
    v_add_f32 v9, 1.0, v9
    v_mfma_f32_16x16x32_bf16 v[68:71], v[196:199], v[216:219], v[68:71]
    v_rcp_f32 v8, v8
    v_mfma_f32_16x16x32_bf16 v[72:75], v[196:199], v[220:223], v[72:75]
    v_rcp_f32 v9, v9
    v_mfma_f32_16x16x32_bf16 v[76:79], v[196:199], v[224:227], v[76:79]
    s_nop 0
    s_waitcnt vmcnt(9)
    v_mfma_f32_16x16x32_bf16 v[80:83], v[200:203], v[212:215], v[80:83]
    v_mul_f32 v0, v0, v8
    v_mfma_f32_16x16x32_bf16 v[84:87], v[200:203], v[216:219], v[84:87]
    v_mul_f32 v1, v1, v9
    v_mfma_f32_16x16x32_bf16 v[88:91], v[200:203], v[220:223], v[88:91]
    v_cvt_pk_bf16_f32 v14, v0, v1
    v_mfma_f32_16x16x32_bf16 v[92:95], v[200:203], v[224:227], v[92:95]
    s_waitcnt vmcnt(8)
    v_mfma_f32_16x16x32_bf16 v[96:99], v[204:207], v[212:215], v[96:99]
    v_mfma_f32_16x16x32_bf16 v[100:103], v[204:207], v[216:219], v[100:103]
    v_mfma_f32_16x16x32_bf16 v[104:107], v[204:207], v[220:223], v[104:107]
    v_mfma_f32_16x16x32_bf16 v[108:111], v[204:207], v[224:227], v[108:111]
    s_waitcnt vmcnt(7)
    v_mfma_f32_16x16x32_bf16 v[112:115], v[208:211], v[212:215], v[112:115]
    v_mfma_f32_16x16x32_bf16 v[116:119], v[208:211], v[216:219], v[116:119]
    v_mfma_f32_16x16x32_bf16 v[120:123], v[208:211], v[220:223], v[120:123]
    v_mfma_f32_16x16x32_bf16 v[124:127], v[208:211], v[224:227], v[124:127]
    s_waitcnt lgkmcnt(0)
    v_mov_b32 v10, 163328
    s_mov_b32 s57, 0x400000
recurrent_scan__ssm_conv_h3__mixer_gmlp__prompt_kernel_lw23:
    ds_read_b32 v5, v10 offset:36
    s_sub_u32 s57, s57, 1
    s_waitcnt lgkmcnt(0)
    v_readfirstlane_b32 s56, v5
    s_cmp_eq_u32 s57, 0
    s_cbranch_scc1 recurrent_scan__ssm_conv_h3__mixer_gmlp__prompt_kernel_lwk24
    s_cmp_ge_u32 s56, 4
    s_cbranch_scc1 recurrent_scan__ssm_conv_h3__mixer_gmlp__prompt_kernel_lwk24
    s_sleep 1
    s_branch recurrent_scan__ssm_conv_h3__mixer_gmlp__prompt_kernel_lw23
recurrent_scan__ssm_conv_h3__mixer_gmlp__prompt_kernel_lwk24:
    s_lshl_b32 s48, s30, 14
    s_add_u32 s48, s48, 0x10000
    v_add_u32 v5, s48, v4
    s_waitcnt vmcnt(0)
    v_add_u32 v10, s60, v4
    v_mfma_f32_16x16x32_bf16 v[28:31], v[128:131], v[240:243], v[28:31]
    v_lshlrev_b32 v0, 16, v15
    v_mfma_f32_16x16x32_bf16 v[44:47], v[132:135], v[240:243], v[44:47]
    v_and_b32 v1, s49, v15
    v_mfma_f32_16x16x32_bf16 v[60:63], v[136:139], v[240:243], v[60:63]
    v_fmaak_f32 v8, v0, v0, 0x41b2e92f
    v_mfma_f32_16x16x32_bf16 v[76:79], v[140:143], v[240:243], v[76:79]
    v_fmaak_f32 v9, v1, v1, 0x41b2e92f
    v_mfma_f32_16x16x32_bf16 v[92:95], v[144:147], v[240:243], v[92:95]
    v_mul_f32 v8, v8, v0
    v_mfma_f32_16x16x32_bf16 v[108:111], v[148:151], v[240:243], v[108:111]
    v_mul_f32 v9, v9, v1
    v_mfma_f32_16x16x32_bf16 v[124:127], v[152:155], v[240:243], v[124:127]
    v_mul_f32 v8, 0xbdd2d3e8, v8
    v_mfma_f32_16x16x32_bf16 v[20:23], v[128:131], v[232:235], v[20:23]
    v_mul_f32 v9, 0xbdd2d3e8, v9
    v_mfma_f32_16x16x32_bf16 v[36:39], v[132:135], v[232:235], v[36:39]
    v_exp_f32 v8, v8
    ds_write_b128 v10, v[28:31] offset:0
    v_mfma_f32_16x16x32_bf16 v[52:55], v[136:139], v[232:235], v[52:55]
    v_exp_f32 v9, v9
    ds_write_b128 v10, v[44:47] offset:1024
    v_mfma_f32_16x16x32_bf16 v[68:71], v[140:143], v[232:235], v[68:71]
    s_nop 0
    ds_write_b128 v10, v[60:63] offset:2048
    v_mfma_f32_16x16x32_bf16 v[84:87], v[144:147], v[232:235], v[84:87]
    v_add_f32 v8, 1.0, v8
    ds_write_b128 v10, v[76:79] offset:3072
    v_mfma_f32_16x16x32_bf16 v[100:103], v[148:151], v[232:235], v[100:103]
    v_add_f32 v9, 1.0, v9
    ds_write_b128 v10, v[92:95] offset:4096
    v_mfma_f32_16x16x32_bf16 v[116:119], v[152:155], v[232:235], v[116:119]
    v_rcp_f32 v8, v8
    ds_write_b128 v10, v[108:111] offset:5120
    v_mfma_f32_16x16x32_bf16 v[24:27], v[128:131], v[236:239], v[24:27]
    v_rcp_f32 v9, v9
    ds_write_b128 v10, v[124:127] offset:6144
    v_mfma_f32_16x16x32_bf16 v[40:43], v[132:135], v[236:239], v[40:43]
    s_nop 0
    ds_write_b128 v10, v[20:23] offset:7168
    v_mfma_f32_16x16x32_bf16 v[56:59], v[136:139], v[236:239], v[56:59]
    v_mul_f32 v0, v0, v8
    ds_write_b128 v10, v[36:39] offset:8192
    v_mfma_f32_16x16x32_bf16 v[72:75], v[140:143], v[236:239], v[72:75]
    v_mul_f32 v1, v1, v9
    ds_write_b128 v10, v[52:55] offset:9216
    v_mfma_f32_16x16x32_bf16 v[88:91], v[144:147], v[236:239], v[88:91]
    v_cvt_pk_bf16_f32 v15, v0, v1
    ds_write_b128 v10, v[68:71] offset:10240
    v_mfma_f32_16x16x32_bf16 v[104:107], v[148:151], v[236:239], v[104:107]
    ds_write_b128 v10, v[84:87] offset:11264
    v_mfma_f32_16x16x32_bf16 v[120:123], v[152:155], v[236:239], v[120:123]
    ds_write_b128 v10, v[100:103] offset:12288
    v_mfma_f32_16x16x32_bf16 v[16:19], v[128:131], v[228:231], v[16:19]
    ds_write_b128 v10, v[116:119] offset:13312
    v_mfma_f32_16x16x32_bf16 v[32:35], v[132:135], v[228:231], v[32:35]
    ds_write_b128 v5, v[24:27] offset:0
    v_mfma_f32_16x16x32_bf16 v[48:51], v[136:139], v[228:231], v[48:51]
    ds_write_b128 v5, v[40:43] offset:1024
    v_mfma_f32_16x16x32_bf16 v[64:67], v[140:143], v[228:231], v[64:67]
    ds_write_b128 v5, v[56:59] offset:2048
    v_mfma_f32_16x16x32_bf16 v[80:83], v[144:147], v[228:231], v[80:83]
    ds_write_b128 v5, v[72:75] offset:3072
    v_mfma_f32_16x16x32_bf16 v[96:99], v[148:151], v[228:231], v[96:99]
    ds_write_b128 v5, v[88:91] offset:4096
    v_mfma_f32_16x16x32_bf16 v[112:115], v[152:155], v[228:231], v[112:115]
    ds_write_b128 v5, v[104:107] offset:5120
    ds_write_b128 v5, v[120:123] offset:6144
    s_xor_b32 s48, s60, 0x4000
    s_xor_b32 s47, s60, 0xc000
    v_add_u32 v12, s48, v4
    v_add_u32 v13, s47, v4
    s_xor_b32 s48, s30, 2
    s_lshl_b32 s48, s48, 14
    s_add_u32 s48, s48, 0x10000
    v_add_u32 v5, s48, v4
    v_lshlrev_b32 v8, 16, v11
    v_lshlrev_b32 v9, 16, v11
    v_mov_b32 v0, 163328
    v_mov_b32 v1, 1
    s_mov_b64 exec, 1
    s_waitcnt lgkmcnt(0)
    ds_add_u32 v0, v1 offset:44
    s_mov_b64 exec, -1
    s_mov_b32 s57, 0x400000
recurrent_scan__ssm_conv_h3__mixer_gmlp__prompt_kernel_lw25:
    ds_read_b32 v1, v0 offset:44
    s_sub_u32 s57, s57, 1
    s_waitcnt lgkmcnt(0)
    v_readfirstlane_b32 s56, v1
    s_cmp_eq_u32 s57, 0
    s_cbranch_scc1 recurrent_scan__ssm_conv_h3__mixer_gmlp__prompt_kernel_lwk26
    s_cmp_ge_u32 s56, 4
    s_cbranch_scc1 recurrent_scan__ssm_conv_h3__mixer_gmlp__prompt_kernel_lwk26
    s_branch recurrent_scan__ssm_conv_h3__mixer_gmlp__prompt_kernel_lw25
recurrent_scan__ssm_conv_h3__mixer_gmlp__prompt_kernel_lwk26:
    ds_read_b128 v[128:131], v12 offset:7168
    ds_read_b128 v[156:159], v13 offset:0
    ds_read_b128 v[184:187], v5 offset:0
    ds_read_b128 v[132:135], v12 offset:8192
    ds_read_b128 v[160:163], v13 offset:1024
    ds_read_b128 v[188:191], v5 offset:1024
    ds_read_b128 v[136:139], v12 offset:9216
    ds_read_b128 v[164:167], v13 offset:2048
    ds_read_b128 v[192:195], v5 offset:2048
    ds_read_b128 v[140:143], v12 offset:10240
    ds_read_b128 v[168:171], v13 offset:3072
    ds_read_b128 v[196:199], v5 offset:3072
    v_lshlrev_b32 v212, 16, v244
    v_and_b32 v213, s49, v244
    v_pk_add_f32 v[16:17], v[16:17], v[8:9]
    v_lshlrev_b32 v214, 16, v245
    v_and_b32 v215, s49, v245
    v_pk_add_f32 v[18:19], v[18:19], v[8:9]
    v_lshlrev_b32 v216, 16, v246
    v_and_b32 v217, s49, v246
    v_pk_add_f32 v[32:33], v[32:33], v[8:9]
    v_lshlrev_b32 v218, 16, v247
    v_and_b32 v219, s49, v247
    v_pk_add_f32 v[34:35], v[34:35], v[8:9]
    v_lshlrev_b32 v220, 16, v248
    v_and_b32 v221, s49, v248
    v_pk_add_f32 v[48:49], v[48:49], v[8:9]
    v_lshlrev_b32 v222, 16, v249
    v_and_b32 v223, s49, v249
    v_pk_add_f32 v[50:51], v[50:51], v[8:9]
    v_lshlrev_b32 v224, 16, v250
    v_and_b32 v225, s49, v250
    v_pk_add_f32 v[64:65], v[64:65], v[8:9]
    v_lshlrev_b32 v226, 16, v251
    v_and_b32 v227, s49, v251
    v_pk_add_f32 v[66:67], v[66:67], v[8:9]
    v_lshlrev_b32 v228, 16, v252
    v_and_b32 v229, s49, v252
    v_pk_add_f32 v[80:81], v[80:81], v[8:9]
    v_lshlrev_b32 v230, 16, v253
    v_and_b32 v231, s49, v253
    v_pk_add_f32 v[82:83], v[82:83], v[8:9]
    v_lshlrev_b32 v232, 16, v254
    v_and_b32 v233, s49, v254
    v_pk_add_f32 v[96:97], v[96:97], v[8:9]
    v_lshlrev_b32 v234, 16, v255
    v_and_b32 v235, s49, v255
    v_pk_add_f32 v[98:99], v[98:99], v[8:9]
    v_lshlrev_b32 v236, 16, v14
    v_and_b32 v237, s49, v14
    v_pk_add_f32 v[112:113], v[112:113], v[8:9]
    v_lshlrev_b32 v238, 16, v15
    v_and_b32 v239, s49, v15
    v_pk_add_f32 v[114:115], v[114:115], v[8:9]
    ds_read_b128 v[144:147], v12 offset:11264
    ds_read_b128 v[172:175], v13 offset:4096
    ds_read_b128 v[200:203], v5 offset:4096
    ds_read_b128 v[148:151], v12 offset:12288
    ds_read_b128 v[176:179], v13 offset:5120
    ds_read_b128 v[204:207], v5 offset:5120
    ds_read_b128 v[152:155], v12 offset:13312
    ds_read_b128 v[180:183], v13 offset:6144
    ds_read_b128 v[208:211], v5 offset:6144
    v_lshrrev_b32 v0, 1, v4
    s_mul_i32 s44, s67, 504
    s_add_u32 s51, s51, s44
    s_waitcnt lgkmcnt(15)
    v_pk_add_f32 v[128:129], v[128:129], v[156:157]
    v_pk_add_f32 v[16:17], v[16:17], v[184:185]
    v_pk_add_f32 v[130:131], v[130:131], v[158:159]
    v_pk_add_f32 v[18:19], v[18:19], v[186:187]
    v_pk_add_f32 v[16:17], v[16:17], v[128:129]
    v_pk_add_f32 v[18:19], v[18:19], v[130:131]
    v_pk_mul_f32 v[16:17], v[16:17], v[212:213]
    v_pk_mul_f32 v[18:19], v[18:19], v[214:215]
    v_cvt_pk_bf16_f32 v244, v16, v17
    v_cvt_pk_bf16_f32 v245, v18, v19
    s_waitcnt lgkmcnt(15)
    v_pk_add_f32 v[132:133], v[132:133], v[160:161]
    v_pk_add_f32 v[32:33], v[32:33], v[188:189]
    v_pk_add_f32 v[134:135], v[134:135], v[162:163]
    v_pk_add_f32 v[34:35], v[34:35], v[190:191]
    v_pk_add_f32 v[32:33], v[32:33], v[132:133]
    v_pk_add_f32 v[34:35], v[34:35], v[134:135]
    v_pk_mul_f32 v[32:33], v[32:33], v[216:217]
    v_pk_mul_f32 v[34:35], v[34:35], v[218:219]
    v_cvt_pk_bf16_f32 v246, v32, v33
    v_cvt_pk_bf16_f32 v247, v34, v35
    buffer_store_dwordx4 v[244:247], v4, s[20:23], s50 offen offset:0 sc1
    s_waitcnt lgkmcnt(12)
    v_pk_add_f32 v[136:137], v[136:137], v[164:165]
    v_pk_add_f32 v[48:49], v[48:49], v[192:193]
    v_pk_add_f32 v[138:139], v[138:139], v[166:167]
    v_pk_add_f32 v[50:51], v[50:51], v[194:195]
    v_pk_add_f32 v[48:49], v[48:49], v[136:137]
    v_pk_add_f32 v[50:51], v[50:51], v[138:139]
    v_pk_mul_f32 v[48:49], v[48:49], v[220:221]
    v_pk_mul_f32 v[50:51], v[50:51], v[222:223]
    v_cvt_pk_bf16_f32 v248, v48, v49
    v_cvt_pk_bf16_f32 v249, v50, v51
    s_waitcnt lgkmcnt(9)
    v_pk_add_f32 v[140:141], v[140:141], v[168:169]
    v_pk_add_f32 v[64:65], v[64:65], v[196:197]
    v_pk_add_f32 v[142:143], v[142:143], v[170:171]
    v_pk_add_f32 v[66:67], v[66:67], v[198:199]
    v_pk_add_f32 v[64:65], v[64:65], v[140:141]
    v_pk_add_f32 v[66:67], v[66:67], v[142:143]
    v_pk_mul_f32 v[64:65], v[64:65], v[224:225]
    v_pk_mul_f32 v[66:67], v[66:67], v[226:227]
    v_cvt_pk_bf16_f32 v250, v64, v65
    v_cvt_pk_bf16_f32 v251, v66, v67
    buffer_store_dwordx4 v[248:251], v4, s[20:23], s50 offen offset:1024 sc1
    s_waitcnt lgkmcnt(6)
    v_pk_add_f32 v[144:145], v[144:145], v[172:173]
    v_pk_add_f32 v[80:81], v[80:81], v[200:201]
    v_pk_add_f32 v[146:147], v[146:147], v[174:175]
    v_pk_add_f32 v[82:83], v[82:83], v[202:203]
    v_pk_add_f32 v[80:81], v[80:81], v[144:145]
    v_pk_add_f32 v[82:83], v[82:83], v[146:147]
    v_pk_mul_f32 v[80:81], v[80:81], v[228:229]
    v_pk_mul_f32 v[82:83], v[82:83], v[230:231]
    v_cvt_pk_bf16_f32 v252, v80, v81
    v_cvt_pk_bf16_f32 v253, v82, v83
    s_waitcnt lgkmcnt(3)
    v_pk_add_f32 v[148:149], v[148:149], v[176:177]
    v_pk_add_f32 v[96:97], v[96:97], v[204:205]
    v_pk_add_f32 v[150:151], v[150:151], v[178:179]
    v_pk_add_f32 v[98:99], v[98:99], v[206:207]
    v_pk_add_f32 v[96:97], v[96:97], v[148:149]
    v_pk_add_f32 v[98:99], v[98:99], v[150:151]
    v_pk_mul_f32 v[96:97], v[96:97], v[232:233]
    v_pk_mul_f32 v[98:99], v[98:99], v[234:235]
    v_cvt_pk_bf16_f32 v254, v96, v97
    v_cvt_pk_bf16_f32 v255, v98, v99
    buffer_store_dwordx4 v[252:255], v4, s[20:23], s50 offen offset:2048 sc1
    s_waitcnt lgkmcnt(0)
    v_pk_add_f32 v[152:153], v[152:153], v[180:181]
    v_pk_add_f32 v[112:113], v[112:113], v[208:209]
    v_pk_add_f32 v[154:155], v[154:155], v[182:183]
    v_pk_add_f32 v[114:115], v[114:115], v[210:211]
    v_pk_add_f32 v[112:113], v[112:113], v[152:153]
    v_pk_add_f32 v[114:115], v[114:115], v[154:155]
    v_pk_mul_f32 v[112:113], v[112:113], v[236:237]
    v_pk_mul_f32 v[114:115], v[114:115], v[238:239]
    v_cvt_pk_bf16_f32 v14, v112, v113
    v_cvt_pk_bf16_f32 v15, v114, v115
    buffer_store_dwordx2 v[14:15], v0, s[20:23], s51 offen sc1
    s_add_u32 s8, s28, 16420864
    s_addc_u32 s9, s29, 0
    s_mov_b32 s10, 270336
    s_mov_b32 s11, 0x00020000
    s_add_u32 s16, s28, 13647872
    s_addc_u32 s17, s29, 0
    s_mov_b32 s18, 1835008
    s_mov_b32 s19, 0x00020000
    s_add_u32 s12, s28, 15482880
    s_addc_u32 s13, s29, 0
    s_mov_b32 s14, 16384
    s_mov_b32 s15, 0x00020000
    s_mov_b32 s24, s84
    s_mov_b32 s25, s85
    s_mov_b32 s26, 1835008
    s_mov_b32 s27, 0x00020000
    s_mov_b32 s36, s86
    s_mov_b32 s37, s87
    s_mov_b32 s38, 1835008
    s_mov_b32 s39, 0x00020000
    v_lshrrev_b32 v2, 4, v4
    v_lshrrev_b32 v6, 3, v2
    v_and_b32 v7, 7, v2
    v_mul_u32_u24 v9, 896, v6
    v_lshl_add_u32 v9, v7, 4, v9
    s_lshl_b32 s43, s33, 6
    s_lshl_b32 s44, s30, 4
    s_add_u32 s43, s43, s44
    s_mul_i32 s44, s43, 896
    s_lshl_b32 s45, s34, 7
    s_add_u32 s44, s44, s45
    s_add_u32 s45, s44, 7168
    s_lshl_b32 s46, s43, 3
    v_lshlrev_b32 v10, 3, v6
    s_lshl_b32 s40, s33, 12
    s_lshl_b32 s41, s34, 9
    s_add_u32 s40, s40, s41
    s_lshl_b32 s41, s30, 7
    s_add_u32 s40, s40, s41
    s_add_u32 s40, s40, 8192
    v_lshlrev_b32 v0, 2, v2
    v_mov_b32 v1, s59
    s_waitcnt vmcnt(0)
    s_mov_b32 exec_hi, 0
    buffer_store_dword v1, v0, s[8:11], s40 offen sc1
    s_mov_b64 exec, -1
    s_cmp_eq_u32 s34, 7
    s_cbranch_scc1 recurrent_scan__ssm_conv_h3__mixer_gmlp__prompt_kernel_gend
    s_barrier
    buffer_load_dwordx4 v[12:15], v9, s[24:27], s44 offen
    buffer_load_dwordx4 v[16:19], v9, s[24:27], s45 offen
    buffer_load_dwordx2 v[20:21], v10, s[12:15], s46 offen sc1
    buffer_load_dwordx2 v[22:23], v10, s[12:15], s46 offen offset:64 sc1
    v_lshlrev_b32 v8, 2, v2
    v_lshlrev_b32 v11, 3, v2
    s_lshl_b32 s41, s34, 9
    s_add_u32 s41, s41, 4096
    s_mov_b32 s42, 65536
recurrent_scan__ssm_conv_h3__mixer_gmlp__prompt_kernel_cvpoll27:
    buffer_load_dwordx2 v[30:31], v11, s[8:11], s41 offen sc1
    s_sub_u32 s42, s42, 1
    s_waitcnt vmcnt(0)
    v_xor_b32 v30, v30, v1
    v_xor_b32 v31, v31, v1
    v_or_b32 v30, v30, v31
    v_cmp_ne_u32 vcc, 0, v30
    s_cmp_eq_u32 s42, 0
    s_cbranch_scc1 recurrent_scan__ssm_conv_h3__mixer_gmlp__prompt_kernel_cvok28
    s_nop 2
    s_cbranch_vccz recurrent_scan__ssm_conv_h3__mixer_gmlp__prompt_kernel_cvok28
    s_sleep 2
    s_branch recurrent_scan__ssm_conv_h3__mixer_gmlp__prompt_kernel_cvpoll27
recurrent_scan__ssm_conv_h3__mixer_gmlp__prompt_kernel_cvok28:
    v_lshrrev_b32 v8, 1, v2
    v_lshlrev_b32 v8, 12, v8
    v_and_b32 v3, 1, v2
    v_lshl_add_u32 v8, v3, 4, v8
    s_lshl_b32 s40, s34, 18
    s_lshl_b32 s41, s43, 1
    s_add_u32 s40, s40, s41
    s_add_u32 s41, s40, 0x20000
    s_lshl_b32 s42, s30, 11
    s_add_u32 s42, s42, 144384
    s_mov_b32 m0, s42
    s_nop 0
    buffer_load_dwordx4 v8, s[16:19], s40 offen sc1 lds
    s_add_u32 m0, s42, 1024
    s_nop 0
    buffer_load_dwordx4 v8, s[16:19], s41 offen sc1 lds
    v_lshlrev_b32 v24, 3, v2
    v_add_u32 v24, s42, v24
    v_and_b32 v25, 15, v2
    v_mul_u32_u24 v25, 144, v25
    v_lshrrev_b32 v3, 4, v2
    v_lshl_add_u32 v25, v3, 3, v25
    s_mul_i32 s48, s30, 2304
    s_add_u32 s48, s48, 152576
    v_add_u32 v25, s48, v25
    v_mul_u32_u24 v26, 144, v6
    v_lshl_add_u32 v26, v7, 4, v26
    v_add_u32 v26, s48, v26
    v_lshrrev_b32 v27, 1, v7
    v_lshlrev_b32 v27, 10, v27
    v_and_b32 v28, 1, v7
    v_lshl_add_u32 v27, v28, 9, v27
    s_mov_b32 s48, s30
    s_and_b32 s48, s48, 3
    s_lshl_b32 s48, s48, 12
    s_add_u32 s48, s48, 0x10000
    v_add_u32 v27, s48, v27
    v_lshl_add_u32 v28, v7, 1, v6
    v_and_b32 v28, 15, v28
    v_lshlrev_b32 v28, 4, v28
    v_xor_b32 v30, 0x80, v28
    v_add_u32 v30, v30, v27
    v_add_u32 v27, v28, v27
    s_mov_b32 s50, 0xbfb8aa3b
    s_mov_b32 s51, 0xbfb8aa3b
    s_mov_b32 s52, 1.0
    s_mov_b32 s53, 1.0
    v_lshlrev_b32 v40, 16, v12
    v_and_b32 v41, s49, v12
    v_lshlrev_b32 v42, 16, v13
    v_and_b32 v43, s49, v13
    v_lshlrev_b32 v44, 16, v14
    v_and_b32 v45, s49, v14
    v_lshlrev_b32 v46, 16, v15
    v_and_b32 v47, s49, v15
    v_lshlrev_b32 v48, 16, v16
    v_and_b32 v49, s49, v16
    v_lshlrev_b32 v50, 16, v17
    v_and_b32 v51, s49, v17
    v_lshlrev_b32 v52, 16, v18
    v_and_b32 v53, s49, v18
    v_lshlrev_b32 v54, 16, v19
    v_and_b32 v55, s49, v19
    s_waitcnt vmcnt(0)
    ds_read_b64_tr_b16 v[32:33], v24 offset:0
    ds_read_b64_tr_b16 v[34:35], v24 offset:512
    ds_read_b64_tr_b16 v[36:37], v24 offset:1024
    ds_read_b64_tr_b16 v[38:39], v24 offset:1536
    s_waitcnt lgkmcnt(3)
    ds_write_b64 v25, v[32:33] offset:0
    s_waitcnt lgkmcnt(3)
    ds_write_b64 v25, v[34:35] offset:32
    s_waitcnt lgkmcnt(3)
    ds_write_b64 v25, v[36:37] offset:64
    s_waitcnt lgkmcnt(3)
    ds_write_b64 v25, v[38:39] offset:96
    s_waitcnt lgkmcnt(0)
    ds_read_b128 v[32:35], v26
    ds_read_b128 v[36:39], v26 offset:1152
    s_waitcnt lgkmcnt(0)
    v_lshlrev_b32 v28, 16, v32
    v_and_b32 v29, s49, v32
    v_sub_f32 v56, v40, v20
    v_mul_f32 v56, v56, v21
    v_mul_f32 v56, v56, v28
    v_sub_f32 v57, v41, v20
    v_mul_f32 v57, v57, v21
    v_mul_f32 v57, v57, v29
    v_lshlrev_b32 v28, 16, v33
    v_and_b32 v29, s49, v33
    v_sub_f32 v58, v42, v20
    v_mul_f32 v58, v58, v21
    v_mul_f32 v58, v58, v28
    v_sub_f32 v59, v43, v20
    v_mul_f32 v59, v59, v21
    v_mul_f32 v59, v59, v29
    v_lshlrev_b32 v28, 16, v34
    v_and_b32 v29, s49, v34
    v_sub_f32 v60, v44, v20
    v_mul_f32 v60, v60, v21
    v_mul_f32 v60, v60, v28
    v_sub_f32 v61, v45, v20
    v_mul_f32 v61, v61, v21
    v_mul_f32 v61, v61, v29
    v_lshlrev_b32 v28, 16, v35
    v_and_b32 v29, s49, v35
    v_sub_f32 v62, v46, v20
    v_mul_f32 v62, v62, v21
    v_mul_f32 v62, v62, v28
    v_sub_f32 v63, v47, v20
    v_mul_f32 v63, v63, v21
    v_mul_f32 v63, v63, v29
    v_lshlrev_b32 v28, 16, v36
    v_and_b32 v29, s49, v36
    v_sub_f32 v64, v48, v22
    v_mul_f32 v64, v64, v23
    v_mul_f32 v64, v64, v28
    v_sub_f32 v65, v49, v22
    v_mul_f32 v65, v65, v23
    v_mul_f32 v65, v65, v29
    v_lshlrev_b32 v28, 16, v37
    v_and_b32 v29, s49, v37
    v_sub_f32 v66, v50, v22
    v_mul_f32 v66, v66, v23
    v_mul_f32 v66, v66, v28
    v_sub_f32 v67, v51, v22
    v_mul_f32 v67, v67, v23
    v_mul_f32 v67, v67, v29
    v_lshlrev_b32 v28, 16, v38
    v_and_b32 v29, s49, v38
    v_sub_f32 v68, v52, v22
    v_mul_f32 v68, v68, v23
    v_mul_f32 v68, v68, v28
    v_sub_f32 v69, v53, v22
    v_mul_f32 v69, v69, v23
    v_mul_f32 v69, v69, v29
    v_lshlrev_b32 v28, 16, v39
    v_and_b32 v29, s49, v39
    v_sub_f32 v70, v54, v22
    v_mul_f32 v70, v70, v23
    v_mul_f32 v70, v70, v28
    v_sub_f32 v71, v55, v22
    v_mul_f32 v71, v71, v23
    v_mul_f32 v71, v71, v29
    s_barrier
    ds_read_b128 v[72:75], v27 offset:0
    ds_read_b128 v[76:79], v27 offset:256
    ds_read_b128 v[80:83], v27 offset:16384
    ds_read_b128 v[84:87], v27 offset:16640
    ds_read_b128 v[88:91], v27 offset:32768
    ds_read_b128 v[92:95], v27 offset:33024
    ds_read_b128 v[96:99], v27 offset:49152
    ds_read_b128 v[100:103], v27 offset:49408
    ds_read_b128 v[104:107], v30 offset:0
    ds_read_b128 v[108:111], v30 offset:256
    ds_read_b128 v[112:115], v30 offset:16384
    ds_read_b128 v[116:119], v30 offset:16640
    ds_read_b128 v[120:123], v30 offset:32768
    ds_read_b128 v[124:127], v30 offset:33024
    ds_read_b128 v[128:131], v30 offset:49152
    ds_read_b128 v[132:135], v30 offset:49408
    s_waitcnt lgkmcnt(8)
    v_pk_add_f32 v[72:73], v[72:73], v[80:81]
    v_pk_add_f32 v[88:89], v[88:89], v[96:97]
    v_pk_add_f32 v[74:75], v[74:75], v[82:83]
    v_pk_add_f32 v[90:91], v[90:91], v[98:99]
    v_pk_add_f32 v[76:77], v[76:77], v[84:85]
    v_pk_add_f32 v[92:93], v[92:93], v[100:101]
    v_pk_add_f32 v[78:79], v[78:79], v[86:87]
    v_pk_add_f32 v[94:95], v[94:95], v[102:103]
    v_pk_add_f32 v[72:73], v[72:73], v[88:89]
    v_pk_add_f32 v[74:75], v[74:75], v[90:91]
    v_pk_add_f32 v[76:77], v[76:77], v[92:93]
    v_pk_add_f32 v[78:79], v[78:79], v[94:95]
    v_pk_mul_f32 v[80:81], v[72:73], s[50:51]
    v_pk_mul_f32 v[82:83], v[74:75], s[50:51]
    v_pk_mul_f32 v[84:85], v[76:77], s[50:51]
    v_pk_mul_f32 v[86:87], v[78:79], s[50:51]
    v_exp_f32 v80, v80
    v_exp_f32 v81, v81
    v_exp_f32 v82, v82
    v_exp_f32 v83, v83
    v_exp_f32 v84, v84
    v_exp_f32 v85, v85
    v_exp_f32 v86, v86
    v_exp_f32 v87, v87
    v_pk_mul_f32 v[72:73], v[72:73], v[56:57]
    v_pk_mul_f32 v[74:75], v[74:75], v[58:59]
    v_pk_mul_f32 v[76:77], v[76:77], v[60:61]
    v_pk_mul_f32 v[78:79], v[78:79], v[62:63]
    v_pk_add_f32 v[80:81], v[80:81], s[52:53]
    v_pk_add_f32 v[82:83], v[82:83], s[52:53]
    v_pk_add_f32 v[84:85], v[84:85], s[52:53]
    v_pk_add_f32 v[86:87], v[86:87], s[52:53]
    v_rcp_f32 v80, v80
    v_rcp_f32 v81, v81
    v_rcp_f32 v82, v82
    v_rcp_f32 v83, v83
    v_rcp_f32 v84, v84
    v_rcp_f32 v85, v85
    v_rcp_f32 v86, v86
    v_rcp_f32 v87, v87
    s_nop 0
    v_pk_fma_f32 v[72:73], v[72:73], v[80:81], v[40:41]
    v_pk_fma_f32 v[74:75], v[74:75], v[82:83], v[42:43]
    v_pk_fma_f32 v[76:77], v[76:77], v[84:85], v[44:45]
    v_pk_fma_f32 v[78:79], v[78:79], v[86:87], v[46:47]
    v_cvt_pk_bf16_f32 v88, v72, v73
    v_cvt_pk_bf16_f32 v89, v74, v75
    v_cvt_pk_bf16_f32 v90, v76, v77
    v_cvt_pk_bf16_f32 v91, v78, v79
    buffer_store_dwordx4 v[88:91], v9, s[36:39], s44 offen sc1
    s_waitcnt lgkmcnt(0)
    v_pk_add_f32 v[104:105], v[104:105], v[112:113]
    v_pk_add_f32 v[120:121], v[120:121], v[128:129]
    v_pk_add_f32 v[106:107], v[106:107], v[114:115]
    v_pk_add_f32 v[122:123], v[122:123], v[130:131]
    v_pk_add_f32 v[108:109], v[108:109], v[116:117]
    v_pk_add_f32 v[124:125], v[124:125], v[132:133]
    v_pk_add_f32 v[110:111], v[110:111], v[118:119]
    v_pk_add_f32 v[126:127], v[126:127], v[134:135]
    v_pk_add_f32 v[104:105], v[104:105], v[120:121]
    v_pk_add_f32 v[106:107], v[106:107], v[122:123]
    v_pk_add_f32 v[108:109], v[108:109], v[124:125]
    v_pk_add_f32 v[110:111], v[110:111], v[126:127]
    v_pk_mul_f32 v[112:113], v[104:105], s[50:51]
    v_pk_mul_f32 v[114:115], v[106:107], s[50:51]
    v_pk_mul_f32 v[116:117], v[108:109], s[50:51]
    v_pk_mul_f32 v[118:119], v[110:111], s[50:51]
    v_exp_f32 v112, v112
    v_exp_f32 v113, v113
    v_exp_f32 v114, v114
    v_exp_f32 v115, v115
    v_exp_f32 v116, v116
    v_exp_f32 v117, v117
    v_exp_f32 v118, v118
    v_exp_f32 v119, v119
    v_pk_mul_f32 v[104:105], v[104:105], v[64:65]
    v_pk_mul_f32 v[106:107], v[106:107], v[66:67]
    v_pk_mul_f32 v[108:109], v[108:109], v[68:69]
    v_pk_mul_f32 v[110:111], v[110:111], v[70:71]
    v_pk_add_f32 v[112:113], v[112:113], s[52:53]
    v_pk_add_f32 v[114:115], v[114:115], s[52:53]
    v_pk_add_f32 v[116:117], v[116:117], s[52:53]
    v_pk_add_f32 v[118:119], v[118:119], s[52:53]
    v_rcp_f32 v112, v112
    v_rcp_f32 v113, v113
    v_rcp_f32 v114, v114
    v_rcp_f32 v115, v115
    v_rcp_f32 v116, v116
    v_rcp_f32 v117, v117
    v_rcp_f32 v118, v118
    v_rcp_f32 v119, v119
    s_nop 0
    v_pk_fma_f32 v[104:105], v[104:105], v[112:113], v[48:49]
    v_pk_fma_f32 v[106:107], v[106:107], v[114:115], v[50:51]
    v_pk_fma_f32 v[108:109], v[108:109], v[116:117], v[52:53]
    v_pk_fma_f32 v[110:111], v[110:111], v[118:119], v[54:55]
    v_cvt_pk_bf16_f32 v120, v104, v105
    v_cvt_pk_bf16_f32 v121, v106, v107
    v_cvt_pk_bf16_f32 v122, v108, v109
    v_cvt_pk_bf16_f32 v123, v110, v111
    buffer_store_dwordx4 v[120:123], v9, s[36:39], s45 offen sc1
recurrent_scan__ssm_conv_h3__mixer_gmlp__prompt_kernel_gend:
    s_endpgm
recurrent_scan__ssm_conv_h3__mixer_gmlp__prompt_kernel_hlp:
    s_load_dwordx4 s[4:7], s[0:1], 32
    s_setprio 3
    v_mov_b32 v101, 0
    buffer_load_dword v100, v101, s[52:55], 0 offen sc1
    s_mov_b32 s89, s30
    s_sub_u32 s30, s30, 4
    s_waitcnt lgkmcnt(0)
    s_cmp_ge_u32 s2, 224
    s_cbranch_scc1 recurrent_scan__ssm_conv_h3__mixer_gmlp__prompt_kernel_nocv
    s_mov_b32 s8, s4
    s_mov_b32 s9, s5
    s_mov_b32 s10, 1835008
    s_mov_b32 s11, 0x00020000
    s_add_u32 s12, s28, 11812864
    s_addc_u32 s13, s29, 0
    s_mov_b32 s14, 1835008
    s_mov_b32 s15, 0x00020000
    s_and_b32 s31, s30, 1
    s_lshr_b32 s32, s30, 1
    s_lshl_b32 s33, s2, 1
    s_add_u32 s33, s33, s31
    s_lshl_b32 s34, s33, 12
    s_mul_i32 s35, s31, 39424
    s_add_u32 s35, s35, 65536
    s_add_u32 s36, s35, 33280
    v_and_b32 v1, 63, v0
    v_lshlrev_b32 v2, 4, v1
    s_lshl_b32 s37, s32, 11
    s_add_u32 s37, s37, s34
    buffer_load_dwordx4 v[16:19], v2, s[8:11], s37 offen offset:0
    buffer_load_dwordx4 v[20:23], v2, s[8:11], s37 offen offset:1024
    s_add_u32 s37, s34, 2032
    s_load_dwordx4 s[40:43], s[4:5], s37
    s_and_b32 s37, s33, -2
    s_lshl_b32 s37, s37, 1
    s_load_dword s38, s[6:7], s37
    v_mov_b32 v4, 0x7fff0000
    s_mul_i32 s44, s32, 192
    s_mul_i32 s45, s32, 3072
    s_add_u32 s45, s45, s36
    v_add_u32 v3, s44, v1
    s_add_u32 s60, s28, 16420864
    s_addc_u32 s61, s29, 0
    s_mov_b32 s62, 270336
    s_mov_b32 s63, 0x00020000
    v_mov_b32 v102, 163328
    s_add_u32 s88, s88, 65536
    s_and_b32 s64, s2, 7
    s_lshr_b32 s65, s2, 3
    s_and_b32 s66, s64, 3
    s_lshl_b32 s66, s66, 2
    s_bfe_u32 s67, s65, 0x20001
    s_add_u32 s66, s66, s67
    s_lshr_b32 s67, s64, 2
    s_lshl_b32 s67, s67, 2
    s_lshr_b32 s65, s65, 3
    s_add_u32 s67, s67, s65
    s_mul_i32 s67, s67, 7
    s_add_u32 s65, s67, 6
    s_lshr_b32 s67, s67, 2
    s_lshr_b32 s65, s65, 2
    v_add_u32 v103, s67, v1
    v_min_u32 v103, s65, v103
    v_writelane_b32 v103, 0, 3
    v_lshlrev_b32 v103, 11, v103
    s_lshl_b32 s66, s66, 7
    s_add_u32 s66, s66, 204800
    v_add_u32 v103, s66, v103
    s_lshr_b32 s64, s2, 5
    s_min_u32 s64, s64, 6
    s_lshl_b32 s64, s64, 9
    s_add_u32 s64, s64, 172032
    v_and_b32 v104, 3, v1
    v_lshlrev_b32 v104, 7, v104
    v_bfe_u32 v105, v1, 3, 1
    v_lshl_add_u32 v104, v105, 16, v104
    v_add_u32 v104, s64, v104
    v_cmp_gt_u32 vcc, 4, v1
    s_nop 1
    v_cndmask_b32 v103, v104, v103, vcc
    s_waitcnt vmcnt(2)
    s_mov_b32 s57, 65536
recurrent_scan__ssm_conv_h3__mixer_gmlp__prompt_kernel_ep29:
    v_readfirstlane_b32 s59, v100
    s_cmp_lg_u32 s59, 0
    s_cbranch_scc1 recurrent_scan__ssm_conv_h3__mixer_gmlp__prompt_kernel_epk30
    s_sub_u32 s57, s57, 1
    s_cmp_eq_u32 s57, 0
    s_cbranch_scc1 recurrent_scan__ssm_conv_h3__mixer_gmlp__prompt_kernel_epk30
    s_sleep 2
    buffer_load_dword v100, v101, s[52:55], 0 offen sc1
    s_waitcnt vmcnt(0)
    s_branch recurrent_scan__ssm_conv_h3__mixer_gmlp__prompt_kernel_ep29
recurrent_scan__ssm_conv_h3__mixer_gmlp__prompt_kernel_epk30:
    v_mov_b32 v104, 1
    s_mov_b64 exec, 1
    ds_add_rtn_u32 v104, v102, v104 offset:24
    s_mov_b64 exec, -1
    v_lshlrev_b32 v105, 2, v1
    s_waitcnt lgkmcnt(0)
    v_readfirstlane_b32 s56, v104
    v_mov_b32 v104, s59
    s_cmp_lg_u32 s56, 3
    s_cbranch_scc1 recurrent_scan__ssm_conv_h3__mixer_gmlp__prompt_kernel_nf31
    s_mov_b32 exec_hi, 0
    buffer_store_dword v104, v105, s[60:63], s88 offen sc1
    s_mov_b64 exec, -1
recurrent_scan__ssm_conv_h3__mixer_gmlp__prompt_kernel_nf31:
    s_mov_b32 s57, 0x400000
recurrent_scan__ssm_conv_h3__mixer_gmlp__prompt_kernel_lw33:
    ds_read_b32 v105, v102 offset:24
    s_sub_u32 s57, s57, 1
    s_waitcnt lgkmcnt(0)
    v_readfirstlane_b32 s56, v105
    s_cmp_eq_u32 s57, 0
    s_cbranch_scc1 recurrent_scan__ssm_conv_h3__mixer_gmlp__prompt_kernel_lwk34
    s_cmp_ge_u32 s56, 4
    s_cbranch_scc1 recurrent_scan__ssm_conv_h3__mixer_gmlp__prompt_kernel_lwk34
    s_sleep 1
    s_branch recurrent_scan__ssm_conv_h3__mixer_gmlp__prompt_kernel_lw33
recurrent_scan__ssm_conv_h3__mixer_gmlp__prompt_kernel_lwk34:
    s_cmp_lg_u32 s30, 0
    s_cbranch_scc1 recurrent_scan__ssm_conv_h3__mixer_gmlp__prompt_kernel_hs32
    s_mov_b64 exec, 0xfff
    s_mov_b32 s57, 65536
recurrent_scan__ssm_conv_h3__mixer_gmlp__prompt_kernel_pl35:
    buffer_load_dword v106, v103, s[60:63], 0 offen sc1
    s_sub_u32 s57, s57, 1
    s_waitcnt vmcnt(0)
    v_cmp_ne_u32 vcc, v106, v104
    s_cmp_eq_u32 s57, 0
    s_cbranch_scc1 recurrent_scan__ssm_conv_h3__mixer_gmlp__prompt_kernel_plk36
    s_nop 2
    s_cbranch_vccz recurrent_scan__ssm_conv_h3__mixer_gmlp__prompt_kernel_plk36
    s_sleep 6
    s_branch recurrent_scan__ssm_conv_h3__mixer_gmlp__prompt_kernel_pl35
recurrent_scan__ssm_conv_h3__mixer_gmlp__prompt_kernel_plk36:
    s_mov_b64 exec, -1
    v_mov_b32 v104, 1
    ds_write_b32 v102, v104 offset:28
recurrent_scan__ssm_conv_h3__mixer_gmlp__prompt_kernel_hs32:
    s_mov_b32 s57, 0x400000
recurrent_scan__ssm_conv_h3__mixer_gmlp__prompt_kernel_lw37:
    ds_read_b32 v104, v102 offset:28
    s_sub_u32 s57, s57, 1
    s_waitcnt lgkmcnt(0)
    v_readfirstlane_b32 s56, v104
    s_cmp_eq_u32 s57, 0
    s_cbranch_scc1 recurrent_scan__ssm_conv_h3__mixer_gmlp__prompt_kernel_lwk38
    s_cmp_ge_u32 s56, 1
    s_cbranch_scc1 recurrent_scan__ssm_conv_h3__mixer_gmlp__prompt_kernel_lwk38
    s_sleep 1
    s_branch recurrent_scan__ssm_conv_h3__mixer_gmlp__prompt_kernel_lw37
recurrent_scan__ssm_conv_h3__mixer_gmlp__prompt_kernel_lwk38:
    s_mov_b32 s57, 0x400000
recurrent_scan__ssm_conv_h3__mixer_gmlp__prompt_kernel_lw39:
    ds_read_b32 v104, v102 offset:4
    s_sub_u32 s57, s57, 1
    s_waitcnt lgkmcnt(0)
    v_readfirstlane_b32 s56, v104
    s_cmp_eq_u32 s57, 0
    s_cbranch_scc1 recurrent_scan__ssm_conv_h3__mixer_gmlp__prompt_kernel_lwk40
    s_cmp_ge_u32 s56, 4
    s_cbranch_scc1 recurrent_scan__ssm_conv_h3__mixer_gmlp__prompt_kernel_lwk40
    s_sleep 1
    s_branch recurrent_scan__ssm_conv_h3__mixer_gmlp__prompt_kernel_lw39
recurrent_scan__ssm_conv_h3__mixer_gmlp__prompt_kernel_lwk40:
    v_add_u32 v5, 0, v3
    v_mul_u32_u24 v6, 1366, v5
    v_lshrrev_b32 v6, 16, v6
    v_mul_u32_u24 v7, 48, v6
    v_sub_u32 v7, v5, v7
    v_cmp_gt_u32 vcc, 16, v7
    v_lshlrev_b32 v6, 5, v6
    v_add_u32 v6, v6, v7
    v_lshlrev_b32 v6, 4, v6
    v_subrev_u32 v6, 256, v6
    s_add_u32 m0, s45, 0
    v_cndmask_b32 v6, v6, v4, vcc
    buffer_load_dwordx4 v6, s[12:15], s34 offen sc1 lds
    v_add_u32 v5, 64, v3
    v_mul_u32_u24 v6, 1366, v5
    v_lshrrev_b32 v6, 16, v6
    v_mul_u32_u24 v7, 48, v6
    v_sub_u32 v7, v5, v7
    v_cmp_gt_u32 vcc, 16, v7
    v_lshlrev_b32 v6, 5, v6
    v_add_u32 v6, v6, v7
    v_lshlrev_b32 v6, 4, v6
    v_subrev_u32 v6, 256, v6
    s_add_u32 m0, s45, 1024
    v_cndmask_b32 v6, v6, v4, vcc
    buffer_load_dwordx4 v6, s[12:15], s34 offen sc1 lds
    v_add_u32 v5, 128, v3
    v_mul_u32_u24 v6, 1366, v5
    v_lshrrev_b32 v6, 16, v6
    v_mul_u32_u24 v7, 48, v6
    v_sub_u32 v7, v5, v7
    v_cmp_gt_u32 vcc, 16, v7
    v_lshlrev_b32 v6, 5, v6
    v_add_u32 v6, v6, v7
    v_lshlrev_b32 v6, 4, v6
    v_subrev_u32 v6, 256, v6
    s_add_u32 m0, s45, 2048
    v_cndmask_b32 v6, v6, v4, vcc
    buffer_load_dwordx4 v6, s[12:15], s34 offen sc1 lds
    s_setprio 0
    s_add_u32 s16, s28, 13647872
    s_addc_u32 s17, s29, 0
    s_mov_b32 s18, 1835008
    s_mov_b32 s19, 0x00020000
    v_lshrrev_b32 v9, 2, v1
    v_mul_u32_u24 v9, 4160, v9
    v_and_b32 v10, 3, v1
    v_lshl_add_u32 v9, v10, 4, v9
    v_add_u32 v9, s35, v9
    v_mov_b32 v12, 0
    v_mov_b32 v13, 0
    v_mov_b32 v14, 0
    v_mov_b32 v15, 0
    s_mov_b32 exec_hi, 0
    ds_write_b128 v9, v[12:15]
    s_mov_b64 exec, -1
    s_lshl_b32 s37, s32, 11
    s_add_u32 s37, s37, s35
    v_add_u32 v9, s37, v2
    s_mov_b32 s39, 0xffff
    s_waitcnt lgkmcnt(0)
    s_cmp_eq_u32 s32, 0
    s_cselect_b32 s40, 0, s40
    s_cselect_b32 s41, 0, s41
    s_cselect_b32 s42, 0, s42
    s_cselect_b32 s43, 0, s43
    s_waitcnt vmcnt(4)
    v_mov_b32_dpp v12, v16 wave_shr:1 row_mask:0xf bank_mask:0xf
    v_mov_b32_dpp v13, v17 wave_shr:1 row_mask:0xf bank_mask:0xf
    v_mov_b32_dpp v14, v18 wave_shr:1 row_mask:0xf bank_mask:0xf
    v_mov_b32_dpp v15, v19 wave_shr:1 row_mask:0xf bank_mask:0xf
    v_writelane_b32 v12, s40, 0
    v_writelane_b32 v13, s41, 0
    v_writelane_b32 v14, s42, 0
    v_writelane_b32 v15, s43, 0
    v_bfi_b32 v48, s39, v19, v18
    v_bfi_b32 v49, s39, v18, v17
    v_bfi_b32 v50, s39, v17, v16
    v_bfi_b32 v51, s39, v16, v15
    v_bfi_b32 v52, s39, v15, v14
    v_bfi_b32 v53, s39, v14, v13
    v_bfi_b32 v58, s39, v18, v17
    v_bfi_b32 v59, s39, v17, v16
    v_bfi_b32 v60, s39, v16, v15
    v_bfi_b32 v61, s39, v15, v14
    v_bfi_b32 v62, s39, v14, v13
    v_bfi_b32 v63, s39, v13, v12
    v_alignbit_b32 v64, v19, v19, 16
    v_alignbit_b32 v65, v18, v18, 16
    v_alignbit_b32 v66, v17, v17, 16
    v_alignbit_b32 v67, v16, v16, 16
    v_alignbit_b32 v68, v15, v15, 16
    v_alignbit_b32 v69, v14, v14, 16
    v_alignbit_b32 v74, v18, v18, 16
    v_alignbit_b32 v75, v17, v17, 16
    v_alignbit_b32 v76, v16, v16, 16
    v_alignbit_b32 v77, v15, v15, 16
    v_alignbit_b32 v78, v14, v14, 16
    v_alignbit_b32 v79, v13, v13, 16
    ds_write_b128 v9, v[60:63] offset:64
    ds_write_b128 v9, v[76:79] offset:4224
    ds_write_b128 v9, v[50:53] offset:8384
    ds_write_b128 v9, v[66:69] offset:12544
    ds_write_b128 v9, v[58:61] offset:16704
    ds_write_b128 v9, v[74:77] offset:20864
    ds_write_b128 v9, v[48:51] offset:25024
    ds_write_b128 v9, v[64:67] offset:29184
    s_waitcnt vmcnt(3)
    v_readlane_b32 s40, v16, 63
    v_readlane_b32 s41, v17, 63
    v_readlane_b32 s42, v18, 63
    v_readlane_b32 s43, v19, 63
    v_mov_b32_dpp v12, v20 wave_shr:1 row_mask:0xf bank_mask:0xf
    v_mov_b32_dpp v13, v21 wave_shr:1 row_mask:0xf bank_mask:0xf
    v_mov_b32_dpp v14, v22 wave_shr:1 row_mask:0xf bank_mask:0xf
    v_mov_b32_dpp v15, v23 wave_shr:1 row_mask:0xf bank_mask:0xf
    v_writelane_b32 v12, s40, 0
    v_writelane_b32 v13, s41, 0
    v_writelane_b32 v14, s42, 0
    v_writelane_b32 v15, s43, 0
    v_bfi_b32 v48, s39, v23, v22
    v_bfi_b32 v49, s39, v22, v21
    v_bfi_b32 v50, s39, v21, v20
    v_bfi_b32 v51, s39, v20, v15
    v_bfi_b32 v52, s39, v15, v14
    v_bfi_b32 v53, s39, v14, v13
    v_bfi_b32 v58, s39, v22, v21
    v_bfi_b32 v59, s39, v21, v20
    v_bfi_b32 v60, s39, v20, v15
    v_bfi_b32 v61, s39, v15, v14
    v_bfi_b32 v62, s39, v14, v13
    v_bfi_b32 v63, s39, v13, v12
    v_alignbit_b32 v64, v23, v23, 16
    v_alignbit_b32 v65, v22, v22, 16
    v_alignbit_b32 v66, v21, v21, 16
    v_alignbit_b32 v67, v20, v20, 16
    v_alignbit_b32 v68, v15, v15, 16
    v_alignbit_b32 v69, v14, v14, 16
    v_alignbit_b32 v74, v22, v22, 16
    v_alignbit_b32 v75, v21, v21, 16
    v_alignbit_b32 v76, v20, v20, 16
    v_alignbit_b32 v77, v15, v15, 16
    v_alignbit_b32 v78, v14, v14, 16
    v_alignbit_b32 v79, v13, v13, 16
    ds_write_b128 v9, v[60:63] offset:1088
    ds_write_b128 v9, v[76:79] offset:5248
    ds_write_b128 v9, v[50:53] offset:9408
    ds_write_b128 v9, v[66:69] offset:13568
    ds_write_b128 v9, v[58:61] offset:17728
    ds_write_b128 v9, v[74:77] offset:21888
    ds_write_b128 v9, v[48:51] offset:26048
    ds_write_b128 v9, v[64:67] offset:30208
    v_and_b32 v10, 7, v1
    v_mul_u32_u24 v10, 260, v10
    v_bfe_u32 v11, v1, 3, 1
    v_add_u32 v10, v10, v11
    v_lshrrev_b32 v11, 4, v1
    v_sub_u32 v10, v10, v11
    v_lshlrev_b32 v10, 4, v10
    s_lshl_b32 s40, s32, 5
    s_add_u32 s40, s40, s35
    s_add_u32 s40, s40, 64
    v_add_u32 v10, s40, v10
    v_mul_u32_u24 v12, 48, v11
    v_and_b32 v13, 15, v1
    v_add_u32 v12, v12, v13
    v_lshlrev_b32 v12, 4, v12
    v_add_u32 v11, s36, v12
    s_lshl_b32 s46, s31, 2
    s_add_u32 s46, s46, 163336
    v_mov_b32 v8, s46
    v_mov_b32 v9, 1
    s_waitcnt vmcnt(0) lgkmcnt(0)
    s_mov_b64 exec, 1
    ds_add_u32 v8, v9 offset:8
    s_mov_b64 exec, -1
    s_mov_b32 s57, 0x400000
recurrent_scan__ssm_conv_h3__mixer_gmlp__prompt_kernel_lw41:
    ds_read_b32 v9, v8 offset:8
    s_sub_u32 s57, s57, 1
    s_waitcnt lgkmcnt(0)
    v_readfirstlane_b32 s56, v9
    s_cmp_eq_u32 s57, 0
    s_cbranch_scc1 recurrent_scan__ssm_conv_h3__mixer_gmlp__prompt_kernel_lwk42
    s_cmp_ge_u32 s56, 2
    s_cbranch_scc1 recurrent_scan__ssm_conv_h3__mixer_gmlp__prompt_kernel_lwk42
    s_sleep 1
    s_branch recurrent_scan__ssm_conv_h3__mixer_gmlp__prompt_kernel_lw41
recurrent_scan__ssm_conv_h3__mixer_gmlp__prompt_kernel_lwk42:
    ds_read_b128 v[96:99], v10 offset:0
    ds_read_b128 v[116:119], v11 offset:3328
    ds_read_b128 v[120:123], v11 offset:3584
    ds_read_b128 v[100:103], v10 offset:64
    ds_read_b128 v[124:127], v11 offset:256
    ds_read_b128 v[128:131], v11 offset:512
    ds_read_b128 v[104:107], v10 offset:128
    ds_read_b128 v[132:135], v11 offset:3312
    ds_read_b128 v[136:139], v11 offset:3568
    ds_read_b128 v[108:111], v10 offset:192
    ds_read_b128 v[140:143], v11 offset:240
    ds_read_b128 v[144:147], v11 offset:496
    s_waitcnt lgkmcnt(9)
    v_mfma_f32_16x16x32_bf16 v[92:95], v[96:99], v[120:123], 0
    v_mfma_f32_16x16x32_bf16 v[84:87], v[96:99], v[116:119], 0
    ds_read_b128 v[112:115], v10 offset:256
    ds_read_b128 v[116:119], v11 offset:3296
    ds_read_b128 v[120:123], v11 offset:3552
    s_waitcnt lgkmcnt(9)
    v_mfma_f32_16x16x32_bf16 v[88:91], v[96:99], v[128:131], 0
    v_mfma_f32_16x16x32_bf16 v[92:95], v[100:103], v[128:131], v[92:95]
    v_mfma_f32_16x16x32_bf16 v[80:83], v[96:99], v[124:127], 0
    v_mfma_f32_16x16x32_bf16 v[84:87], v[100:103], v[124:127], v[84:87]
    ds_read_b128 v[96:99], v10 offset:320
    ds_read_b128 v[124:127], v11 offset:224
    ds_read_b128 v[128:131], v11 offset:480
    s_waitcnt lgkmcnt(9)
    v_mfma_f32_16x16x32_bf16 v[88:91], v[100:103], v[136:139], v[88:91]
    v_mfma_f32_16x16x32_bf16 v[92:95], v[104:107], v[136:139], v[92:95]
    v_mfma_f32_16x16x32_bf16 v[80:83], v[100:103], v[132:135], v[80:83]
    v_mfma_f32_16x16x32_bf16 v[84:87], v[104:107], v[132:135], v[84:87]
    ds_read_b128 v[100:103], v10 offset:384
    ds_read_b128 v[132:135], v11 offset:3280
    ds_read_b128 v[136:139], v11 offset:3536
    s_waitcnt lgkmcnt(9)
    v_mfma_f32_16x16x32_bf16 v[88:91], v[104:107], v[144:147], v[88:91]
    v_mfma_f32_16x16x32_bf16 v[92:95], v[108:111], v[144:147], v[92:95]
    v_mfma_f32_16x16x32_bf16 v[80:83], v[104:107], v[140:143], v[80:83]
    v_mfma_f32_16x16x32_bf16 v[84:87], v[108:111], v[140:143], v[84:87]
    ds_read_b128 v[104:107], v10 offset:448
    ds_read_b128 v[140:143], v11 offset:208
    ds_read_b128 v[144:147], v11 offset:464
    s_waitcnt lgkmcnt(9)
    v_mfma_f32_16x16x32_bf16 v[88:91], v[108:111], v[120:123], v[88:91]
    v_mfma_f32_16x16x32_bf16 v[92:95], v[112:115], v[120:123], v[92:95]
    v_mfma_f32_16x16x32_bf16 v[80:83], v[108:111], v[116:119], v[80:83]
    v_mfma_f32_16x16x32_bf16 v[84:87], v[112:115], v[116:119], v[84:87]
    ds_read_b128 v[108:111], v10 offset:512
    ds_read_b128 v[116:119], v11 offset:3264
    ds_read_b128 v[120:123], v11 offset:3520
    s_waitcnt lgkmcnt(9)
    v_mfma_f32_16x16x32_bf16 v[88:91], v[112:115], v[128:131], v[88:91]
    v_mfma_f32_16x16x32_bf16 v[92:95], v[96:99], v[128:131], v[92:95]
    v_mfma_f32_16x16x32_bf16 v[80:83], v[112:115], v[124:127], v[80:83]
    v_mfma_f32_16x16x32_bf16 v[84:87], v[96:99], v[124:127], v[84:87]
    ds_read_b128 v[112:115], v10 offset:576
    ds_read_b128 v[124:127], v11 offset:192
    ds_read_b128 v[128:131], v11 offset:448
    s_waitcnt lgkmcnt(9)
    v_mfma_f32_16x16x32_bf16 v[88:91], v[96:99], v[136:139], v[88:91]
    v_mfma_f32_16x16x32_bf16 v[92:95], v[100:103], v[136:139], v[92:95]
    v_mfma_f32_16x16x32_bf16 v[80:83], v[96:99], v[132:135], v[80:83]
    v_mfma_f32_16x16x32_bf16 v[84:87], v[100:103], v[132:135], v[84:87]
    ds_read_b128 v[96:99], v10 offset:640
    ds_read_b128 v[132:135], v11 offset:3248
    ds_read_b128 v[136:139], v11 offset:3504
    s_waitcnt lgkmcnt(9)
    v_mfma_f32_16x16x32_bf16 v[88:91], v[100:103], v[144:147], v[88:91]
    v_mfma_f32_16x16x32_bf16 v[92:95], v[104:107], v[144:147], v[92:95]
    v_mfma_f32_16x16x32_bf16 v[80:83], v[100:103], v[140:143], v[80:83]
    v_mfma_f32_16x16x32_bf16 v[84:87], v[104:107], v[140:143], v[84:87]
    ds_read_b128 v[100:103], v10 offset:704
    ds_read_b128 v[140:143], v11 offset:176
    ds_read_b128 v[144:147], v11 offset:432
    s_waitcnt lgkmcnt(9)
    v_mfma_f32_16x16x32_bf16 v[88:91], v[104:107], v[120:123], v[88:91]
    v_mfma_f32_16x16x32_bf16 v[92:95], v[108:111], v[120:123], v[92:95]
    v_mfma_f32_16x16x32_bf16 v[80:83], v[104:107], v[116:119], v[80:83]
    v_mfma_f32_16x16x32_bf16 v[84:87], v[108:111], v[116:119], v[84:87]
    ds_read_b128 v[104:107], v10 offset:768
    ds_read_b128 v[116:119], v11 offset:3232
    ds_read_b128 v[120:123], v11 offset:3488
    s_waitcnt lgkmcnt(9)
    v_mfma_f32_16x16x32_bf16 v[88:91], v[108:111], v[128:131], v[88:91]
    v_mfma_f32_16x16x32_bf16 v[92:95], v[112:115], v[128:131], v[92:95]
    v_mfma_f32_16x16x32_bf16 v[80:83], v[108:111], v[124:127], v[80:83]
    v_mfma_f32_16x16x32_bf16 v[84:87], v[112:115], v[124:127], v[84:87]
    ds_read_b128 v[108:111], v10 offset:832
    ds_read_b128 v[124:127], v11 offset:160
    ds_read_b128 v[128:131], v11 offset:416
    s_waitcnt lgkmcnt(9)
    v_mfma_f32_16x16x32_bf16 v[88:91], v[112:115], v[136:139], v[88:91]
    v_mfma_f32_16x16x32_bf16 v[92:95], v[96:99], v[136:139], v[92:95]
    v_mfma_f32_16x16x32_bf16 v[80:83], v[112:115], v[132:135], v[80:83]
    v_mfma_f32_16x16x32_bf16 v[84:87], v[96:99], v[132:135], v[84:87]
    ds_read_b128 v[112:115], v10 offset:896
    ds_read_b128 v[132:135], v11 offset:3216
    ds_read_b128 v[136:139], v11 offset:3472
    s_waitcnt lgkmcnt(9)
    v_mfma_f32_16x16x32_bf16 v[88:91], v[96:99], v[144:147], v[88:91]
    v_mfma_f32_16x16x32_bf16 v[92:95], v[100:103], v[144:147], v[92:95]
    v_mfma_f32_16x16x32_bf16 v[80:83], v[96:99], v[140:143], v[80:83]
    v_mfma_f32_16x16x32_bf16 v[84:87], v[100:103], v[140:143], v[84:87]
    ds_read_b128 v[96:99], v10 offset:960
    ds_read_b128 v[140:143], v11 offset:144
    ds_read_b128 v[144:147], v11 offset:400
    s_waitcnt lgkmcnt(9)
    v_mfma_f32_16x16x32_bf16 v[88:91], v[100:103], v[120:123], v[88:91]
    v_mfma_f32_16x16x32_bf16 v[92:95], v[104:107], v[120:123], v[92:95]
    v_mfma_f32_16x16x32_bf16 v[80:83], v[100:103], v[116:119], v[80:83]
    v_mfma_f32_16x16x32_bf16 v[84:87], v[104:107], v[116:119], v[84:87]
    ds_read_b128 v[100:103], v10 offset:1024
    ds_read_b128 v[116:119], v11 offset:3200
    ds_read_b128 v[120:123], v11 offset:3456
    s_waitcnt lgkmcnt(9)
    v_mfma_f32_16x16x32_bf16 v[88:91], v[104:107], v[128:131], v[88:91]
    v_mfma_f32_16x16x32_bf16 v[92:95], v[108:111], v[128:131], v[92:95]
    v_mfma_f32_16x16x32_bf16 v[80:83], v[104:107], v[124:127], v[80:83]
    v_mfma_f32_16x16x32_bf16 v[84:87], v[108:111], v[124:127], v[84:87]
    ds_read_b128 v[104:107], v10 offset:1088
    ds_read_b128 v[124:127], v11 offset:128
    ds_read_b128 v[128:131], v11 offset:384
    s_waitcnt lgkmcnt(9)
    v_mfma_f32_16x16x32_bf16 v[88:91], v[108:111], v[136:139], v[88:91]
    v_mfma_f32_16x16x32_bf16 v[92:95], v[112:115], v[136:139], v[92:95]
    v_mfma_f32_16x16x32_bf16 v[80:83], v[108:111], v[132:135], v[80:83]
    v_mfma_f32_16x16x32_bf16 v[84:87], v[112:115], v[132:135], v[84:87]
    ds_read_b128 v[108:111], v10 offset:1152
    ds_read_b128 v[132:135], v11 offset:3184
    ds_read_b128 v[136:139], v11 offset:3440
    s_waitcnt lgkmcnt(9)
    v_mfma_f32_16x16x32_bf16 v[88:91], v[112:115], v[144:147], v[88:91]
    v_mfma_f32_16x16x32_bf16 v[92:95], v[96:99], v[144:147], v[92:95]
    v_mfma_f32_16x16x32_bf16 v[80:83], v[112:115], v[140:143], v[80:83]
    v_mfma_f32_16x16x32_bf16 v[84:87], v[96:99], v[140:143], v[84:87]
    ds_read_b128 v[112:115], v10 offset:1216
    ds_read_b128 v[140:143], v11 offset:112
    ds_read_b128 v[144:147], v11 offset:368
    s_waitcnt lgkmcnt(9)
    v_mfma_f32_16x16x32_bf16 v[88:91], v[96:99], v[120:123], v[88:91]
    v_mfma_f32_16x16x32_bf16 v[92:95], v[100:103], v[120:123], v[92:95]
    v_mfma_f32_16x16x32_bf16 v[80:83], v[96:99], v[116:119], v[80:83]
    v_mfma_f32_16x16x32_bf16 v[84:87], v[100:103], v[116:119], v[84:87]
    ds_read_b128 v[96:99], v10 offset:1280
    ds_read_b128 v[116:119], v11 offset:3168
    ds_read_b128 v[120:123], v11 offset:3424
    s_waitcnt lgkmcnt(9)
    v_mfma_f32_16x16x32_bf16 v[88:91], v[100:103], v[128:131], v[88:91]
    v_mfma_f32_16x16x32_bf16 v[92:95], v[104:107], v[128:131], v[92:95]
    v_mfma_f32_16x16x32_bf16 v[80:83], v[100:103], v[124:127], v[80:83]
    v_mfma_f32_16x16x32_bf16 v[84:87], v[104:107], v[124:127], v[84:87]
    ds_read_b128 v[100:103], v10 offset:1344
    ds_read_b128 v[124:127], v11 offset:96
    ds_read_b128 v[128:131], v11 offset:352
    s_waitcnt lgkmcnt(9)
    v_mfma_f32_16x16x32_bf16 v[88:91], v[104:107], v[136:139], v[88:91]
    v_mfma_f32_16x16x32_bf16 v[92:95], v[108:111], v[136:139], v[92:95]
    v_mfma_f32_16x16x32_bf16 v[80:83], v[104:107], v[132:135], v[80:83]
    v_mfma_f32_16x16x32_bf16 v[84:87], v[108:111], v[132:135], v[84:87]
    ds_read_b128 v[104:107], v10 offset:1408
    ds_read_b128 v[132:135], v11 offset:3152
    ds_read_b128 v[136:139], v11 offset:3408
    s_waitcnt lgkmcnt(9)
    v_mfma_f32_16x16x32_bf16 v[88:91], v[108:111], v[144:147], v[88:91]
    v_mfma_f32_16x16x32_bf16 v[92:95], v[112:115], v[144:147], v[92:95]
    v_mfma_f32_16x16x32_bf16 v[80:83], v[108:111], v[140:143], v[80:83]
    v_mfma_f32_16x16x32_bf16 v[84:87], v[112:115], v[140:143], v[84:87]
    ds_read_b128 v[108:111], v10 offset:1472
    ds_read_b128 v[140:143], v11 offset:80
    ds_read_b128 v[144:147], v11 offset:336
    s_waitcnt lgkmcnt(9)
    v_mfma_f32_16x16x32_bf16 v[88:91], v[112:115], v[120:123], v[88:91]
    v_mfma_f32_16x16x32_bf16 v[92:95], v[96:99], v[120:123], v[92:95]
    v_mfma_f32_16x16x32_bf16 v[80:83], v[112:115], v[116:119], v[80:83]
    v_mfma_f32_16x16x32_bf16 v[84:87], v[96:99], v[116:119], v[84:87]
    ds_read_b128 v[112:115], v10 offset:1536
    ds_read_b128 v[116:119], v11 offset:3136
    ds_read_b128 v[120:123], v11 offset:3392
    s_waitcnt lgkmcnt(9)
    v_mfma_f32_16x16x32_bf16 v[88:91], v[96:99], v[128:131], v[88:91]
    v_mfma_f32_16x16x32_bf16 v[92:95], v[100:103], v[128:131], v[92:95]
    v_mfma_f32_16x16x32_bf16 v[80:83], v[96:99], v[124:127], v[80:83]
    v_mfma_f32_16x16x32_bf16 v[84:87], v[100:103], v[124:127], v[84:87]
    ds_read_b128 v[96:99], v10 offset:1600
    ds_read_b128 v[124:127], v11 offset:64
    ds_read_b128 v[128:131], v11 offset:320
    s_waitcnt lgkmcnt(9)
    v_mfma_f32_16x16x32_bf16 v[88:91], v[100:103], v[136:139], v[88:91]
    v_mfma_f32_16x16x32_bf16 v[92:95], v[104:107], v[136:139], v[92:95]
    v_mfma_f32_16x16x32_bf16 v[80:83], v[100:103], v[132:135], v[80:83]
    v_mfma_f32_16x16x32_bf16 v[84:87], v[104:107], v[132:135], v[84:87]
    ds_read_b128 v[100:103], v10 offset:1664
    ds_read_b128 v[132:135], v11 offset:3120
    ds_read_b128 v[136:139], v11 offset:3376
    s_waitcnt lgkmcnt(9)
    v_mfma_f32_16x16x32_bf16 v[88:91], v[104:107], v[144:147], v[88:91]
    v_mfma_f32_16x16x32_bf16 v[92:95], v[108:111], v[144:147], v[92:95]
    v_mfma_f32_16x16x32_bf16 v[80:83], v[104:107], v[140:143], v[80:83]
    v_mfma_f32_16x16x32_bf16 v[84:87], v[108:111], v[140:143], v[84:87]
    ds_read_b128 v[104:107], v10 offset:1728
    ds_read_b128 v[140:143], v11 offset:48
    ds_read_b128 v[144:147], v11 offset:304
    s_waitcnt lgkmcnt(9)
    v_mfma_f32_16x16x32_bf16 v[88:91], v[108:111], v[120:123], v[88:91]
    v_mfma_f32_16x16x32_bf16 v[92:95], v[112:115], v[120:123], v[92:95]
    v_mfma_f32_16x16x32_bf16 v[80:83], v[108:111], v[116:119], v[80:83]
    v_mfma_f32_16x16x32_bf16 v[84:87], v[112:115], v[116:119], v[84:87]
    ds_read_b128 v[108:111], v10 offset:1792
    ds_read_b128 v[116:119], v11 offset:3104
    ds_read_b128 v[120:123], v11 offset:3360
    s_waitcnt lgkmcnt(9)
    v_mfma_f32_16x16x32_bf16 v[88:91], v[112:115], v[128:131], v[88:91]
    v_mfma_f32_16x16x32_bf16 v[92:95], v[96:99], v[128:131], v[92:95]
    v_mfma_f32_16x16x32_bf16 v[80:83], v[112:115], v[124:127], v[80:83]
    v_mfma_f32_16x16x32_bf16 v[84:87], v[96:99], v[124:127], v[84:87]
    ds_read_b128 v[112:115], v10 offset:1856
    ds_read_b128 v[124:127], v11 offset:32
    ds_read_b128 v[128:131], v11 offset:288
    s_waitcnt lgkmcnt(9)
    v_mfma_f32_16x16x32_bf16 v[88:91], v[96:99], v[136:139], v[88:91]
    v_mfma_f32_16x16x32_bf16 v[92:95], v[100:103], v[136:139], v[92:95]
    v_mfma_f32_16x16x32_bf16 v[80:83], v[96:99], v[132:135], v[80:83]
    v_mfma_f32_16x16x32_bf16 v[84:87], v[100:103], v[132:135], v[84:87]
    ds_read_b128 v[96:99], v10 offset:1920
    ds_read_b128 v[132:135], v11 offset:3088
    ds_read_b128 v[136:139], v11 offset:3344
    s_waitcnt lgkmcnt(9)
    v_mfma_f32_16x16x32_bf16 v[88:91], v[100:103], v[144:147], v[88:91]
    v_mfma_f32_16x16x32_bf16 v[92:95], v[104:107], v[144:147], v[92:95]
    v_mfma_f32_16x16x32_bf16 v[80:83], v[100:103], v[140:143], v[80:83]
    v_mfma_f32_16x16x32_bf16 v[84:87], v[104:107], v[140:143], v[84:87]
    ds_read_b128 v[100:103], v10 offset:1984
    ds_read_b128 v[140:143], v11 offset:16
    ds_read_b128 v[144:147], v11 offset:272
    s_waitcnt lgkmcnt(9)
    v_mfma_f32_16x16x32_bf16 v[88:91], v[104:107], v[120:123], v[88:91]
    v_mfma_f32_16x16x32_bf16 v[92:95], v[108:111], v[120:123], v[92:95]
    v_mfma_f32_16x16x32_bf16 v[80:83], v[104:107], v[116:119], v[80:83]
    v_mfma_f32_16x16x32_bf16 v[84:87], v[108:111], v[116:119], v[84:87]
    ds_read_b128 v[104:107], v10 offset:2048
    ds_read_b128 v[120:123], v11 offset:3328
    s_waitcnt lgkmcnt(8)
    v_mfma_f32_16x16x32_bf16 v[88:91], v[108:111], v[128:131], v[88:91]
    v_mfma_f32_16x16x32_bf16 v[92:95], v[112:115], v[128:131], v[92:95]
    v_mfma_f32_16x16x32_bf16 v[80:83], v[108:111], v[124:127], v[80:83]
    v_mfma_f32_16x16x32_bf16 v[84:87], v[112:115], v[124:127], v[84:87]
    ds_read_b128 v[108:111], v10 offset:2112
    ds_read_b128 v[128:131], v11 offset:256
    s_waitcnt lgkmcnt(7)
    v_mfma_f32_16x16x32_bf16 v[88:91], v[112:115], v[136:139], v[88:91]
    v_mfma_f32_16x16x32_bf16 v[92:95], v[96:99], v[136:139], v[92:95]
    v_mfma_f32_16x16x32_bf16 v[80:83], v[112:115], v[132:135], v[80:83]
    v_mfma_f32_16x16x32_bf16 v[84:87], v[96:99], v[132:135], v[84:87]
    ds_read_b128 v[112:115], v10 offset:2176
    ds_read_b128 v[136:139], v11 offset:3312
    s_waitcnt lgkmcnt(6)
    v_mfma_f32_16x16x32_bf16 v[88:91], v[96:99], v[144:147], v[88:91]
    v_mfma_f32_16x16x32_bf16 v[92:95], v[100:103], v[144:147], v[92:95]
    v_mfma_f32_16x16x32_bf16 v[80:83], v[96:99], v[140:143], v[80:83]
    v_mfma_f32_16x16x32_bf16 v[84:87], v[100:103], v[140:143], v[84:87]
    ds_read_b128 v[96:99], v10 offset:2240
    ds_read_b128 v[144:147], v11 offset:240
    s_waitcnt lgkmcnt(6)
    v_mfma_f32_16x16x32_bf16 v[88:91], v[100:103], v[120:123], v[88:91]
    v_mfma_f32_16x16x32_bf16 v[92:95], v[104:107], v[120:123], v[92:95]
    ds_read_b128 v[100:103], v10 offset:2304
    ds_read_b128 v[120:123], v11 offset:3296
    s_waitcnt lgkmcnt(6)
    v_mfma_f32_16x16x32_bf16 v[88:91], v[104:107], v[128:131], v[88:91]
    v_mfma_f32_16x16x32_bf16 v[92:95], v[108:111], v[128:131], v[92:95]
    ds_read_b128 v[104:107], v10 offset:2368
    ds_read_b128 v[128:131], v11 offset:224
    s_waitcnt lgkmcnt(6)
    v_mfma_f32_16x16x32_bf16 v[88:91], v[108:111], v[136:139], v[88:91]
    v_mfma_f32_16x16x32_bf16 v[92:95], v[112:115], v[136:139], v[92:95]
    ds_read_b128 v[108:111], v10 offset:2432
    ds_read_b128 v[136:139], v11 offset:3280
    s_waitcnt lgkmcnt(6)
    v_mfma_f32_16x16x32_bf16 v[88:91], v[112:115], v[144:147], v[88:91]
    v_mfma_f32_16x16x32_bf16 v[92:95], v[96:99], v[144:147], v[92:95]
    ds_read_b128 v[112:115], v10 offset:2496
    ds_read_b128 v[144:147], v11 offset:208
    s_waitcnt lgkmcnt(6)
    v_mfma_f32_16x16x32_bf16 v[88:91], v[96:99], v[120:123], v[88:91]
    v_mfma_f32_16x16x32_bf16 v[92:95], v[100:103], v[120:123], v[92:95]
    ds_read_b128 v[96:99], v10 offset:2560
    ds_read_b128 v[120:123], v11 offset:3264
    s_waitcnt lgkmcnt(6)
    v_mfma_f32_16x16x32_bf16 v[88:91], v[100:103], v[128:131], v[88:91]
    v_mfma_f32_16x16x32_bf16 v[92:95], v[104:107], v[128:131], v[92:95]
    ds_read_b128 v[100:103], v10 offset:2624
    ds_read_b128 v[128:131], v11 offset:192
    s_waitcnt lgkmcnt(6)
    v_mfma_f32_16x16x32_bf16 v[88:91], v[104:107], v[136:139], v[88:91]
    v_mfma_f32_16x16x32_bf16 v[92:95], v[108:111], v[136:139], v[92:95]
    ds_read_b128 v[104:107], v10 offset:2688
    ds_read_b128 v[136:139], v11 offset:3248
    s_waitcnt lgkmcnt(6)
    v_mfma_f32_16x16x32_bf16 v[88:91], v[108:111], v[144:147], v[88:91]
    v_mfma_f32_16x16x32_bf16 v[92:95], v[112:115], v[144:147], v[92:95]
    ds_read_b128 v[108:111], v10 offset:2752
    ds_read_b128 v[144:147], v11 offset:176
    s_waitcnt lgkmcnt(6)
    v_mfma_f32_16x16x32_bf16 v[88:91], v[112:115], v[120:123], v[88:91]
    v_mfma_f32_16x16x32_bf16 v[92:95], v[96:99], v[120:123], v[92:95]
    ds_read_b128 v[112:115], v10 offset:2816
    ds_read_b128 v[120:123], v11 offset:3232
    s_waitcnt lgkmcnt(6)
    v_mfma_f32_16x16x32_bf16 v[88:91], v[96:99], v[128:131], v[88:91]
    v_mfma_f32_16x16x32_bf16 v[92:95], v[100:103], v[128:131], v[92:95]
    ds_read_b128 v[96:99], v10 offset:2880
    ds_read_b128 v[128:131], v11 offset:160
    s_waitcnt lgkmcnt(6)
    v_mfma_f32_16x16x32_bf16 v[88:91], v[100:103], v[136:139], v[88:91]
    v_mfma_f32_16x16x32_bf16 v[92:95], v[104:107], v[136:139], v[92:95]
    ds_read_b128 v[100:103], v10 offset:2944
    ds_read_b128 v[136:139], v11 offset:3216
    s_waitcnt lgkmcnt(6)
    v_mfma_f32_16x16x32_bf16 v[88:91], v[104:107], v[144:147], v[88:91]
    v_mfma_f32_16x16x32_bf16 v[92:95], v[108:111], v[144:147], v[92:95]
    ds_read_b128 v[104:107], v10 offset:3008
    ds_read_b128 v[144:147], v11 offset:144
    s_waitcnt lgkmcnt(6)
    v_mfma_f32_16x16x32_bf16 v[88:91], v[108:111], v[120:123], v[88:91]
    v_mfma_f32_16x16x32_bf16 v[92:95], v[112:115], v[120:123], v[92:95]
    ds_read_b128 v[108:111], v10 offset:3072
    ds_read_b128 v[120:123], v11 offset:3200
    s_waitcnt lgkmcnt(6)
    v_mfma_f32_16x16x32_bf16 v[88:91], v[112:115], v[128:131], v[88:91]
    v_mfma_f32_16x16x32_bf16 v[92:95], v[96:99], v[128:131], v[92:95]
    ds_read_b128 v[112:115], v10 offset:3136
    ds_read_b128 v[128:131], v11 offset:128
    s_waitcnt lgkmcnt(6)
    v_mfma_f32_16x16x32_bf16 v[88:91], v[96:99], v[136:139], v[88:91]
    v_mfma_f32_16x16x32_bf16 v[92:95], v[100:103], v[136:139], v[92:95]
    ds_read_b128 v[96:99], v10 offset:3200
    ds_read_b128 v[136:139], v11 offset:3184
    s_waitcnt lgkmcnt(6)
    v_mfma_f32_16x16x32_bf16 v[88:91], v[100:103], v[144:147], v[88:91]
    v_mfma_f32_16x16x32_bf16 v[92:95], v[104:107], v[144:147], v[92:95]
    ds_read_b128 v[100:103], v10 offset:3264
    ds_read_b128 v[144:147], v11 offset:112
    s_waitcnt lgkmcnt(6)
    v_mfma_f32_16x16x32_bf16 v[88:91], v[104:107], v[120:123], v[88:91]
    v_mfma_f32_16x16x32_bf16 v[92:95], v[108:111], v[120:123], v[92:95]
    ds_read_b128 v[104:107], v10 offset:3328
    ds_read_b128 v[120:123], v11 offset:3168
    s_waitcnt lgkmcnt(6)
    v_mfma_f32_16x16x32_bf16 v[88:91], v[108:111], v[128:131], v[88:91]
    v_mfma_f32_16x16x32_bf16 v[92:95], v[112:115], v[128:131], v[92:95]
    ds_read_b128 v[108:111], v10 offset:3392
    ds_read_b128 v[128:131], v11 offset:96
    s_waitcnt lgkmcnt(6)
    v_mfma_f32_16x16x32_bf16 v[88:91], v[112:115], v[136:139], v[88:91]
    v_mfma_f32_16x16x32_bf16 v[92:95], v[96:99], v[136:139], v[92:95]
    ds_read_b128 v[112:115], v10 offset:3456
    ds_read_b128 v[136:139], v11 offset:3152
    s_waitcnt lgkmcnt(6)
    v_mfma_f32_16x16x32_bf16 v[88:91], v[96:99], v[144:147], v[88:91]
    v_mfma_f32_16x16x32_bf16 v[92:95], v[100:103], v[144:147], v[92:95]
    ds_read_b128 v[96:99], v10 offset:3520
    ds_read_b128 v[144:147], v11 offset:80
    s_waitcnt lgkmcnt(6)
    v_mfma_f32_16x16x32_bf16 v[88:91], v[100:103], v[120:123], v[88:91]
    v_mfma_f32_16x16x32_bf16 v[92:95], v[104:107], v[120:123], v[92:95]
    ds_read_b128 v[100:103], v10 offset:3584
    ds_read_b128 v[120:123], v11 offset:3136
    s_waitcnt lgkmcnt(6)
    v_mfma_f32_16x16x32_bf16 v[88:91], v[104:107], v[128:131], v[88:91]
    v_mfma_f32_16x16x32_bf16 v[92:95], v[108:111], v[128:131], v[92:95]
    ds_read_b128 v[104:107], v10 offset:3648
    ds_read_b128 v[128:131], v11 offset:64
    s_waitcnt lgkmcnt(6)
    v_mfma_f32_16x16x32_bf16 v[88:91], v[108:111], v[136:139], v[88:91]
    v_mfma_f32_16x16x32_bf16 v[92:95], v[112:115], v[136:139], v[92:95]
    ds_read_b128 v[108:111], v10 offset:3712
    ds_read_b128 v[136:139], v11 offset:3120
    s_waitcnt lgkmcnt(6)
    v_mfma_f32_16x16x32_bf16 v[88:91], v[112:115], v[144:147], v[88:91]
    v_mfma_f32_16x16x32_bf16 v[92:95], v[96:99], v[144:147], v[92:95]
    ds_read_b128 v[112:115], v10 offset:3776
    ds_read_b128 v[144:147], v11 offset:48
    s_waitcnt lgkmcnt(6)
    v_mfma_f32_16x16x32_bf16 v[88:91], v[96:99], v[120:123], v[88:91]
    v_mfma_f32_16x16x32_bf16 v[92:95], v[100:103], v[120:123], v[92:95]
    ds_read_b128 v[96:99], v10 offset:3840
    ds_read_b128 v[120:123], v11 offset:3104
    s_waitcnt lgkmcnt(6)
    v_mfma_f32_16x16x32_bf16 v[88:91], v[100:103], v[128:131], v[88:91]
    v_mfma_f32_16x16x32_bf16 v[92:95], v[104:107], v[128:131], v[92:95]
    ds_read_b128 v[100:103], v10 offset:3904
    ds_read_b128 v[128:131], v11 offset:32
    s_waitcnt lgkmcnt(6)
    v_mfma_f32_16x16x32_bf16 v[88:91], v[104:107], v[136:139], v[88:91]
    v_mfma_f32_16x16x32_bf16 v[92:95], v[108:111], v[136:139], v[92:95]
    ds_read_b128 v[104:107], v10 offset:3968
    ds_read_b128 v[136:139], v11 offset:3088
    s_waitcnt lgkmcnt(6)
    v_mfma_f32_16x16x32_bf16 v[88:91], v[108:111], v[144:147], v[88:91]
    v_mfma_f32_16x16x32_bf16 v[92:95], v[112:115], v[144:147], v[92:95]
    ds_read_b128 v[108:111], v10 offset:4032
    ds_read_b128 v[144:147], v11 offset:16
    s_waitcnt lgkmcnt(6)
    v_mfma_f32_16x16x32_bf16 v[88:91], v[112:115], v[120:123], v[88:91]
    v_mfma_f32_16x16x32_bf16 v[92:95], v[96:99], v[120:123], v[92:95]
    s_waitcnt lgkmcnt(4)
    v_mfma_f32_16x16x32_bf16 v[88:91], v[96:99], v[128:131], v[88:91]
    v_mfma_f32_16x16x32_bf16 v[92:95], v[100:103], v[128:131], v[92:95]
    s_waitcnt lgkmcnt(2)
    v_mfma_f32_16x16x32_bf16 v[88:91], v[100:103], v[136:139], v[88:91]
    v_mfma_f32_16x16x32_bf16 v[92:95], v[104:107], v[136:139], v[92:95]
    s_waitcnt lgkmcnt(0)
    v_mfma_f32_16x16x32_bf16 v[88:91], v[104:107], v[144:147], v[88:91]
    v_mfma_f32_16x16x32_bf16 v[92:95], v[108:111], v[144:147], v[92:95]
    s_setprio 3
    v_lshrrev_b32 v12, 5, v1
    v_mul_u32_u24 v12, 48, v12
    v_add_u32 v12, v12, v13
    v_lshlrev_b32 v12, 4, v12
    v_bfe_u32 v14, v1, 4, 1
    v_lshl_add_u32 v12, v14, 3, v12
    s_mul_i32 s40, s32, 1536
    s_add_u32 s40, s40, s36
    v_add_u32 v12, s40, v12
    ds_read_b64 v[16:17], v12 offset:256
    ds_read_b64 v[18:19], v12 offset:3328
    ds_read_b64 v[20:21], v12 offset:512
    ds_read_b64 v[22:23], v12 offset:3584
    s_mul_i32 s41, s31, 4608
    s_add_u32 s41, s41, 144384
    v_mul_u32_u24 v14, 144, v13
    v_lshrrev_b32 v15, 4, v1
    v_lshl_add_u32 v14, v15, 3, v14
    s_lshl_b32 s40, s32, 5
    s_add_u32 s40, s40, s41
    v_add_u32 v14, s40, v14
    s_lshl_b32 s40, s38, 16
    s_and_b32 s42, s38, 0xffff0000
    s_bitcmp1_b32 s33, 0
    s_cselect_b32 s40, s42, s40
    s_mov_b32 s42, 0xffff0000
    s_waitcnt lgkmcnt(0)
    v_lshlrev_b32 v40, 16, v16
    v_and_b32 v41, s42, v16
    v_fmac_f32 v80, s40, v40
    v_fmac_f32 v81, s40, v41
    v_cvt_pk_bf16_f32 v16, v80, v81
    v_lshlrev_b32 v40, 16, v17
    v_and_b32 v41, s42, v17
    v_fmac_f32 v82, s40, v40
    v_fmac_f32 v83, s40, v41
    v_cvt_pk_bf16_f32 v17, v82, v83
    ds_write_b64 v14, v[16:17] offset:0
    v_lshlrev_b32 v40, 16, v18
    v_and_b32 v41, s42, v18
    v_fmac_f32 v84, s40, v40
    v_fmac_f32 v85, s40, v41
    v_cvt_pk_bf16_f32 v18, v84, v85
    v_lshlrev_b32 v40, 16, v19
    v_and_b32 v41, s42, v19
    v_fmac_f32 v86, s40, v40
    v_fmac_f32 v87, s40, v41
    v_cvt_pk_bf16_f32 v19, v86, v87
    ds_write_b64 v14, v[18:19] offset:64
    v_lshlrev_b32 v40, 16, v20
    v_and_b32 v41, s42, v20
    v_fmac_f32 v88, s40, v40
    v_fmac_f32 v89, s40, v41
    v_cvt_pk_bf16_f32 v20, v88, v89
    v_lshlrev_b32 v40, 16, v21
    v_and_b32 v41, s42, v21
    v_fmac_f32 v90, s40, v40
    v_fmac_f32 v91, s40, v41
    v_cvt_pk_bf16_f32 v21, v90, v91
    ds_write_b64 v14, v[20:21] offset:2304
    v_lshlrev_b32 v40, 16, v22
    v_and_b32 v41, s42, v22
    v_fmac_f32 v92, s40, v40
    v_fmac_f32 v93, s40, v41
    v_cvt_pk_bf16_f32 v22, v92, v93
    v_lshlrev_b32 v40, 16, v23
    v_and_b32 v41, s42, v23
    v_fmac_f32 v94, s40, v40
    v_fmac_f32 v95, s40, v41
    v_cvt_pk_bf16_f32 v23, v94, v95
    ds_write_b64 v14, v[22:23] offset:2368
    s_add_u32 s8, s28, 16420864
    s_addc_u32 s9, s29, 0
    s_mov_b32 s10, 270336
    s_mov_b32 s11, 0x00020000
    v_mov_b32 v9, 1
    s_waitcnt lgkmcnt(0)
    s_mov_b64 exec, 1
    ds_add_u32 v8, v9
    s_mov_b64 exec, -1
    v_lshrrev_b32 v15, 3, v1
    v_mul_u32_u24 v15, 144, v15
    v_and_b32 v12, 7, v1
    v_lshl_add_u32 v15, v12, 4, v15
    s_mul_i32 s40, s32, 2304
    s_add_u32 s40, s40, s41
    v_add_u32 v15, s40, v15
    s_lshl_b32 s40, s32, 11
    s_add_u32 s40, s40, s34
    s_mov_b32 s43, 0x400000
recurrent_scan__ssm_conv_h3__mixer_gmlp__prompt_kernel_cvp43:
    ds_read_b32 v9, v8
    s_sub_u32 s43, s43, 1
    s_waitcnt lgkmcnt(0)
    v_readfirstlane_b32 s42, v9
    s_cmp_eq_u32 s43, 0
    s_cbranch_scc1 recurrent_scan__ssm_conv_h3__mixer_gmlp__prompt_kernel_cvo44
    s_cmp_ge_u32 s42, 2
    s_cbranch_scc1 recurrent_scan__ssm_conv_h3__mixer_gmlp__prompt_kernel_cvo44
    s_sleep 2
    s_branch recurrent_scan__ssm_conv_h3__mixer_gmlp__prompt_kernel_cvp43
recurrent_scan__ssm_conv_h3__mixer_gmlp__prompt_kernel_cvo44:
    ds_read_b128 v[24:27], v15
    ds_read_b128 v[28:31], v15 offset:1152
    s_waitcnt lgkmcnt(1)
    buffer_store_dwordx4 v[24:27], v2, s[16:19], s40 offen sc1
    s_waitcnt lgkmcnt(0)
    buffer_store_dwordx4 v[28:31], v2, s[16:19], s40 offen offset:1024 sc1
    s_lshl_b32 s40, s33, 3
    s_lshl_b32 s41, s32, 2
    s_add_u32 s40, s40, s41
    s_add_u32 s40, s40, 4096
    v_mov_b32 v4, 0
    v_mov_b32 v5, s59
    s_waitcnt vmcnt(0)
    s_mov_b64 exec, 1
    buffer_store_dword v5, v4, s[8:11], s40 offen sc1
    s_mov_b64 exec, -1
    s_branch recurrent_scan__ssm_conv_h3__mixer_gmlp__prompt_kernel_cvd
recurrent_scan__ssm_conv_h3__mixer_gmlp__prompt_kernel_nocv:
    v_and_b32 v1, 63, v0
    s_add_u32 s60, s28, 16420864
    s_addc_u32 s61, s29, 0
    s_mov_b32 s62, 270336
    s_mov_b32 s63, 0x00020000
    v_mov_b32 v102, 163328
    s_add_u32 s88, s88, 65536
    s_and_b32 s64, s2, 7
    s_lshr_b32 s65, s2, 3
    s_and_b32 s66, s64, 3
    s_lshl_b32 s66, s66, 2
    s_bfe_u32 s67, s65, 0x20001
    s_add_u32 s66, s66, s67
    s_lshr_b32 s67, s64, 2
    s_lshl_b32 s67, s67, 2
    s_lshr_b32 s65, s65, 3
    s_add_u32 s67, s67, s65
    s_mul_i32 s67, s67, 7
    s_add_u32 s65, s67, 6
    s_lshr_b32 s67, s67, 2
    s_lshr_b32 s65, s65, 2
    v_add_u32 v103, s67, v1
    v_min_u32 v103, s65, v103
    v_writelane_b32 v103, 0, 3
    v_lshlrev_b32 v103, 11, v103
    s_lshl_b32 s66, s66, 7
    s_add_u32 s66, s66, 204800
    v_add_u32 v103, s66, v103
    s_lshr_b32 s64, s2, 5
    s_min_u32 s64, s64, 6
    s_lshl_b32 s64, s64, 9
    s_add_u32 s64, s64, 172032
    v_and_b32 v104, 3, v1
    v_lshlrev_b32 v104, 7, v104
    v_bfe_u32 v105, v1, 3, 1
    v_lshl_add_u32 v104, v105, 16, v104
    v_add_u32 v104, s64, v104
    v_cmp_gt_u32 vcc, 4, v1
    s_nop 1
    v_cndmask_b32 v103, v104, v103, vcc
    s_waitcnt vmcnt(0)
    s_mov_b32 s57, 65536
recurrent_scan__ssm_conv_h3__mixer_gmlp__prompt_kernel_ep45:
    v_readfirstlane_b32 s59, v100
    s_cmp_lg_u32 s59, 0
    s_cbranch_scc1 recurrent_scan__ssm_conv_h3__mixer_gmlp__prompt_kernel_epk46
    s_sub_u32 s57, s57, 1
    s_cmp_eq_u32 s57, 0
    s_cbranch_scc1 recurrent_scan__ssm_conv_h3__mixer_gmlp__prompt_kernel_epk46
    s_sleep 2
    buffer_load_dword v100, v101, s[52:55], 0 offen sc1
    s_waitcnt vmcnt(0)
    s_branch recurrent_scan__ssm_conv_h3__mixer_gmlp__prompt_kernel_ep45
recurrent_scan__ssm_conv_h3__mixer_gmlp__prompt_kernel_epk46:
    v_mov_b32 v104, 1
    s_mov_b64 exec, 1
    ds_add_rtn_u32 v104, v102, v104 offset:24
    s_mov_b64 exec, -1
    v_lshlrev_b32 v105, 2, v1
    s_waitcnt lgkmcnt(0)
    v_readfirstlane_b32 s56, v104
    v_mov_b32 v104, s59
    s_cmp_lg_u32 s56, 3
    s_cbranch_scc1 recurrent_scan__ssm_conv_h3__mixer_gmlp__prompt_kernel_nf47
    s_mov_b32 exec_hi, 0
    buffer_store_dword v104, v105, s[60:63], s88 offen sc1
    s_mov_b64 exec, -1
recurrent_scan__ssm_conv_h3__mixer_gmlp__prompt_kernel_nf47:
    s_mov_b32 s57, 0x400000
recurrent_scan__ssm_conv_h3__mixer_gmlp__prompt_kernel_lw49:
    ds_read_b32 v105, v102 offset:24
    s_sub_u32 s57, s57, 1
    s_waitcnt lgkmcnt(0)
    v_readfirstlane_b32 s56, v105
    s_cmp_eq_u32 s57, 0
    s_cbranch_scc1 recurrent_scan__ssm_conv_h3__mixer_gmlp__prompt_kernel_lwk50
    s_cmp_ge_u32 s56, 4
    s_cbranch_scc1 recurrent_scan__ssm_conv_h3__mixer_gmlp__prompt_kernel_lwk50
    s_sleep 1
    s_branch recurrent_scan__ssm_conv_h3__mixer_gmlp__prompt_kernel_lw49
recurrent_scan__ssm_conv_h3__mixer_gmlp__prompt_kernel_lwk50:
    s_cmp_lg_u32 s30, 0
    s_cbranch_scc1 recurrent_scan__ssm_conv_h3__mixer_gmlp__prompt_kernel_hs48
    s_mov_b64 exec, 0xfff
    s_mov_b32 s57, 65536
recurrent_scan__ssm_conv_h3__mixer_gmlp__prompt_kernel_pl51:
    buffer_load_dword v106, v103, s[60:63], 0 offen sc1
    s_sub_u32 s57, s57, 1
    s_waitcnt vmcnt(0)
    v_cmp_ne_u32 vcc, v106, v104
    s_cmp_eq_u32 s57, 0
    s_cbranch_scc1 recurrent_scan__ssm_conv_h3__mixer_gmlp__prompt_kernel_plk52
    s_nop 2
    s_cbranch_vccz recurrent_scan__ssm_conv_h3__mixer_gmlp__prompt_kernel_plk52
    s_sleep 6
    s_branch recurrent_scan__ssm_conv_h3__mixer_gmlp__prompt_kernel_pl51
recurrent_scan__ssm_conv_h3__mixer_gmlp__prompt_kernel_plk52:
    s_mov_b64 exec, -1
    v_mov_b32 v104, 1
    ds_write_b32 v102, v104 offset:28
recurrent_scan__ssm_conv_h3__mixer_gmlp__prompt_kernel_hs48:
    s_mov_b32 s57, 0x400000
recurrent_scan__ssm_conv_h3__mixer_gmlp__prompt_kernel_lw53:
    ds_read_b32 v104, v102 offset:28
    s_sub_u32 s57, s57, 1
    s_waitcnt lgkmcnt(0)
    v_readfirstlane_b32 s56, v104
    s_cmp_eq_u32 s57, 0
    s_cbranch_scc1 recurrent_scan__ssm_conv_h3__mixer_gmlp__prompt_kernel_lwk54
    s_cmp_ge_u32 s56, 1
    s_cbranch_scc1 recurrent_scan__ssm_conv_h3__mixer_gmlp__prompt_kernel_lwk54
    s_sleep 1
    s_branch recurrent_scan__ssm_conv_h3__mixer_gmlp__prompt_kernel_lw53
recurrent_scan__ssm_conv_h3__mixer_gmlp__prompt_kernel_lwk54:
    s_mov_b32 s57, 0x400000
recurrent_scan__ssm_conv_h3__mixer_gmlp__prompt_kernel_lw55:
    ds_read_b32 v104, v102 offset:4
    s_sub_u32 s57, s57, 1
    s_waitcnt lgkmcnt(0)
    v_readfirstlane_b32 s56, v104
    s_cmp_eq_u32 s57, 0
    s_cbranch_scc1 recurrent_scan__ssm_conv_h3__mixer_gmlp__prompt_kernel_lwk56
    s_cmp_ge_u32 s56, 4
    s_cbranch_scc1 recurrent_scan__ssm_conv_h3__mixer_gmlp__prompt_kernel_lwk56
    s_sleep 1
    s_branch recurrent_scan__ssm_conv_h3__mixer_gmlp__prompt_kernel_lw55
recurrent_scan__ssm_conv_h3__mixer_gmlp__prompt_kernel_lwk56:
recurrent_scan__ssm_conv_h3__mixer_gmlp__prompt_kernel_cvd:
    v_mov_b32 v4, 163328
    v_mov_b32 v5, 1
    s_mov_b64 exec, 1
    ds_add_u32 v4, v5 offset:36
    s_mov_b64 exec, -1
    s_waitcnt lgkmcnt(0)
    s_and_b32 s31, s2, 7
    s_lshr_b32 s32, s2, 3
    s_and_b32 s33, s31, 3
    s_lshl_b32 s33, s33, 3
    s_and_b32 s34, s32, 7
    s_add_u32 s33, s33, s34
    s_lshr_b32 s34, s31, 2
    s_lshl_b32 s34, s34, 2
    s_lshr_b32 s35, s32, 3
    s_add_u32 s34, s34, s35
    s_cmp_eq_u32 s34, 7
    s_cbranch_scc1 recurrent_scan__ssm_conv_h3__mixer_gmlp__prompt_kernel_end
    s_add_u32 s8, s28, 7340032
    s_addc_u32 s9, s29, 0
    s_mov_b32 s10, 3670016
    s_mov_b32 s11, 0x00020000
    s_add_u32 s12, s28, 11010048
    s_addc_u32 s13, s29, 0
    s_mov_b32 s14, 802816
    s_mov_b32 s15, 0x00020000
    s_add_u32 s16, s28, 16420864
    s_addc_u32 s17, s29, 0
    s_mov_b32 s18, 270336
    s_mov_b32 s19, 0x00020000
    v_and_b32 v2, 63, v0
    v_lshlrev_b32 v4, 4, v2
    v_add_u32 v5, 0x1000, v4
    s_mul_i32 s47, s30, 7168
    s_lshl_b32 s48, s34, 2
    s_add_u32 s48, s48, 0
    s_mul_i32 s48, s48, 28672
    s_add_u32 s50, s48, s47
    s_mov_b32 s49, 0
    s_lshl_b32 s48, s33, 2
    s_add_u32 s48, s48, s49
    s_mul_i32 s48, s48, 28672
    s_add_u32 s54, s48, s47
    s_lshl_b32 s48, s34, 2
    s_add_u32 s48, s48, 1
    s_mul_i32 s48, s48, 28672
    s_add_u32 s51, s48, s47
    s_mov_b32 s49, 1
    s_lshl_b32 s48, s33, 2
    s_add_u32 s48, s48, s49
    s_mul_i32 s48, s48, 28672
    s_add_u32 s55, s48, s47
    s_lshl_b32 s48, s34, 2
    s_add_u32 s48, s48, 2
    s_mul_i32 s48, s48, 28672
    s_add_u32 s52, s48, s47
    s_mov_b32 s49, 2
    s_lshl_b32 s48, s33, 2
    s_add_u32 s48, s48, s49
    s_mul_i32 s48, s48, 28672
    s_add_u32 s56, s48, s47
    s_lshl_b32 s48, s34, 2
    s_add_u32 s48, s48, 3
    s_mul_i32 s48, s48, 28672
    s_add_u32 s53, s48, s47
    s_mov_b32 s49, 3
    s_lshl_b32 s48, s33, 2
    s_add_u32 s48, s48, s49
    s_mul_i32 s48, s48, 28672
    s_add_u32 s57, s48, s47
    s_lshl_b32 s48, s30, 14
    s_add_u32 s48, s48, 0x10000
    v_and_b32 v6, 0x300, v4
    v_add_u32 v6, s48, v6
    v_lshrrev_b32 v3, 5, v2
    v_lshl_add_u32 v3, v3, 1, v2
    v_and_b32 v1, 15, v3
    v_lshl_add_u32 v248, v1, 4, v6
    v_add_u32 v3, 4, v3
    v_and_b32 v1, 15, v3
    v_lshl_add_u32 v249, v1, 4, v6
    v_add_u32 v3, 4, v3
    v_and_b32 v1, 15, v3
    v_lshl_add_u32 v250, v1, 4, v6
    v_add_u32 v3, 4, v3
    v_and_b32 v1, 15, v3
    v_lshl_add_u32 v251, v1, 4, v6
    v_and_b32 v7, 7, v2
    v_lshlrev_b32 v7, 7, v7
    s_lshl_b32 s40, s33, 12
    s_lshl_b32 s41, s30, 10
    s_add_u32 s40, s40, s41
    s_add_u32 s40, s40, 8192
    v_mov_b32 v1, s59
    v_min_u32 v8, 6, v2
    v_mul_u32_u24 v8, 7, v8
    s_mul_i32 s41, s30, 49
    s_add_u32 s41, s41, s34
    v_add_u32 v8, s41, v8
    v_mul_u32_u24 v9, 4682, v8
    v_lshrrev_b32 v9, 16, v9
    v_mul_u32_u24 v10, 14, v9
    v_sub_u32 v10, v8, v10
    v_lshl_add_u32 v8, v10, 4, v9
    v_lshlrev_b32 v8, 7, v8
    s_mov_b32 s41, 204800
    s_mov_b64 exec, 0x7f
    s_mov_b32 s42, 65536
recurrent_scan__ssm_conv_h3__mixer_gmlp__prompt_kernel_pl57:
    buffer_load_dword v12, v8, s[16:19], s41 offen sc1
    s_sub_u32 s42, s42, 1
    s_waitcnt vmcnt(0)
    v_cmp_ne_u32 vcc, v12, v1
    s_cmp_eq_u32 s42, 0
    s_cbranch_scc1 recurrent_scan__ssm_conv_h3__mixer_gmlp__prompt_kernel_plk58
    s_nop 2
    s_cbranch_vccz recurrent_scan__ssm_conv_h3__mixer_gmlp__prompt_kernel_plk58
    s_sleep 8
    s_branch recurrent_scan__ssm_conv_h3__mixer_gmlp__prompt_kernel_pl57
recurrent_scan__ssm_conv_h3__mixer_gmlp__prompt_kernel_plk58:
    s_mov_b64 exec, 0xff
    buffer_load_dword v3, v7, s[16:19], s40 offen sc1
    s_mov_b64 exec, -1
    s_setprio 0
    v_mov_b32 v8, 163328
    s_mov_b32 s42, 0x400000
recurrent_scan__ssm_conv_h3__mixer_gmlp__prompt_kernel_lw59:
    ds_read_b32 v9, v8 offset:40
    s_sub_u32 s42, s42, 1
    s_waitcnt lgkmcnt(0)
    v_readfirstlane_b32 s41, v9
    s_cmp_eq_u32 s42, 0
    s_cbranch_scc1 recurrent_scan__ssm_conv_h3__mixer_gmlp__prompt_kernel_lwk60
    s_cmp_ge_u32 s41, 4
    s_cbranch_scc1 recurrent_scan__ssm_conv_h3__mixer_gmlp__prompt_kernel_lwk60
    s_sleep 4
    s_branch recurrent_scan__ssm_conv_h3__mixer_gmlp__prompt_kernel_lw59
recurrent_scan__ssm_conv_h3__mixer_gmlp__prompt_kernel_lwk60:
    buffer_load_dwordx4 v[72:75], v4, s[12:15], s50 offen offset:0 sc1
    buffer_load_dwordx4 v[76:79], v4, s[12:15], s51 offen offset:0 sc1
    buffer_load_dwordx4 v[80:83], v4, s[12:15], s52 offen offset:0 sc1
    buffer_load_dwordx4 v[84:87], v4, s[12:15], s53 offen offset:0 sc1
    buffer_load_dwordx4 v[88:91], v4, s[12:15], s50 offen offset:1024 sc1
    buffer_load_dwordx4 v[92:95], v4, s[12:15], s51 offen offset:1024 sc1
    buffer_load_dwordx4 v[96:99], v4, s[12:15], s52 offen offset:1024 sc1
    buffer_load_dwordx4 v[100:103], v4, s[12:15], s53 offen offset:1024 sc1
    buffer_load_dwordx4 v[104:107], v4, s[12:15], s50 offen offset:2048 sc1
    buffer_load_dwordx4 v[108:111], v4, s[12:15], s51 offen offset:2048 sc1
    buffer_load_dwordx4 v[112:115], v4, s[12:15], s52 offen offset:2048 sc1
    buffer_load_dwordx4 v[116:119], v4, s[12:15], s53 offen offset:2048 sc1
    buffer_load_dwordx4 v[120:123], v4, s[12:15], s50 offen offset:3072 sc1
    buffer_load_dwordx4 v[124:127], v4, s[12:15], s51 offen offset:3072 sc1
    buffer_load_dwordx4 v[128:131], v4, s[12:15], s52 offen offset:3072 sc1
    buffer_load_dwordx4 v[132:135], v4, s[12:15], s53 offen offset:3072 sc1
    buffer_load_dwordx4 v[136:139], v5, s[12:15], s50 offen offset:0 sc1
    buffer_load_dwordx4 v[140:143], v5, s[12:15], s51 offen offset:0 sc1
    buffer_load_dwordx4 v[144:147], v5, s[12:15], s52 offen offset:0 sc1
    buffer_load_dwordx4 v[148:151], v5, s[12:15], s53 offen offset:0 sc1
    buffer_load_dwordx4 v[152:155], v5, s[12:15], s50 offen offset:1024 sc1
    buffer_load_dwordx4 v[156:159], v5, s[12:15], s51 offen offset:1024 sc1
    buffer_load_dwordx4 v[160:163], v5, s[12:15], s52 offen offset:1024 sc1
    buffer_load_dwordx4 v[164:167], v5, s[12:15], s53 offen offset:1024 sc1
    buffer_load_dwordx4 v[168:171], v5, s[12:15], s50 offen offset:2048 sc1
    buffer_load_dwordx4 v[172:175], v5, s[12:15], s51 offen offset:2048 sc1
    buffer_load_dwordx4 v[176:179], v5, s[12:15], s52 offen offset:2048 sc1
    buffer_load_dwordx4 v[180:183], v5, s[12:15], s53 offen offset:2048 sc1
    s_barrier
    s_mov_b32 s42, 65536
    s_mov_b64 exec, 0xff
recurrent_scan__ssm_conv_h3__mixer_gmlp__prompt_kernel_ppoll61:
    buffer_load_dword v3, v7, s[16:19], s40 offen sc1
    s_sub_u32 s42, s42, 1
    s_waitcnt vmcnt(0)
    v_cmp_ne_u32 vcc, v3, v1
    s_cmp_eq_u32 s42, 0
    s_cbranch_scc1 recurrent_scan__ssm_conv_h3__mixer_gmlp__prompt_kernel_pok62
    s_nop 2
    s_cbranch_vccz recurrent_scan__ssm_conv_h3__mixer_gmlp__prompt_kernel_pok62
    s_sleep 1
    s_branch recurrent_scan__ssm_conv_h3__mixer_gmlp__prompt_kernel_ppoll61
recurrent_scan__ssm_conv_h3__mixer_gmlp__prompt_kernel_pok62:
    s_mov_b64 exec, -1
    v_lshrrev_b32 v3, 1, v4
    buffer_load_dwordx4 v[184:187], v4, s[8:11], s54 offen offset:0 sc1
    buffer_load_dwordx4 v[188:191], v4, s[8:11], s55 offen offset:0 sc1
    buffer_load_dwordx4 v[192:195], v4, s[8:11], s56 offen offset:0 sc1
    buffer_load_dwordx4 v[196:199], v4, s[8:11], s57 offen offset:0 sc1
    buffer_load_dwordx4 v[200:203], v4, s[8:11], s54 offen offset:1024 sc1
    buffer_load_dwordx4 v[204:207], v4, s[8:11], s55 offen offset:1024 sc1
    buffer_load_dwordx4 v[208:211], v4, s[8:11], s56 offen offset:1024 sc1
    buffer_load_dwordx4 v[212:215], v4, s[8:11], s57 offen offset:1024 sc1
    buffer_load_dwordx4 v[216:219], v4, s[8:11], s54 offen offset:2048 sc1
    buffer_load_dwordx4 v[220:223], v4, s[8:11], s55 offen offset:2048 sc1
    buffer_load_dwordx4 v[224:227], v4, s[8:11], s56 offen offset:2048 sc1
    buffer_load_dwordx4 v[228:231], v4, s[8:11], s57 offen offset:2048 sc1
    buffer_load_dwordx2 v[232:233], v3, s[8:11], s54 offen offset:3072 sc1
    buffer_load_dwordx2 v[234:235], v3, s[8:11], s54 offen offset:3584 sc1
    buffer_load_dwordx2 v[236:237], v3, s[8:11], s55 offen offset:3072 sc1
    buffer_load_dwordx2 v[238:239], v3, s[8:11], s55 offen offset:3584 sc1
    buffer_load_dwordx2 v[240:241], v3, s[8:11], s56 offen offset:3072 sc1
    buffer_load_dwordx2 v[242:243], v3, s[8:11], s56 offen offset:3584 sc1
    buffer_load_dwordx2 v[244:245], v3, s[8:11], s57 offen offset:3072 sc1
    buffer_load_dwordx2 v[246:247], v3, s[8:11], s57 offen offset:3584 sc1
    s_waitcnt vmcnt(16)
    v_mfma_f32_16x16x32_bf16 v[8:11], v[72:75], v[184:187], 0
    v_mfma_f32_16x16x32_bf16 v[24:27], v[76:79], v[184:187], 0
    v_mfma_f32_16x16x32_bf16 v[40:43], v[80:83], v[184:187], 0
    v_mfma_f32_16x16x32_bf16 v[56:59], v[84:87], v[184:187], 0
    buffer_load_dwordx4 v[184:187], v5, s[8:11], s54 offen offset:0 sc1
    v_mfma_f32_16x16x32_bf16 v[12:15], v[72:75], v[188:191], 0
    v_mfma_f32_16x16x32_bf16 v[28:31], v[76:79], v[188:191], 0
    v_mfma_f32_16x16x32_bf16 v[44:47], v[80:83], v[188:191], 0
    v_mfma_f32_16x16x32_bf16 v[60:63], v[84:87], v[188:191], 0
    buffer_load_dwordx4 v[188:191], v5, s[8:11], s55 offen offset:0 sc1
    v_mfma_f32_16x16x32_bf16 v[16:19], v[72:75], v[192:195], 0
    v_mfma_f32_16x16x32_bf16 v[32:35], v[76:79], v[192:195], 0
    v_mfma_f32_16x16x32_bf16 v[48:51], v[80:83], v[192:195], 0
    v_mfma_f32_16x16x32_bf16 v[64:67], v[84:87], v[192:195], 0
    buffer_load_dwordx4 v[192:195], v5, s[8:11], s56 offen offset:0 sc1
    v_mfma_f32_16x16x32_bf16 v[20:23], v[72:75], v[196:199], 0
    v_mfma_f32_16x16x32_bf16 v[36:39], v[76:79], v[196:199], 0
    v_mfma_f32_16x16x32_bf16 v[52:55], v[80:83], v[196:199], 0
    v_mfma_f32_16x16x32_bf16 v[68:71], v[84:87], v[196:199], 0
    buffer_load_dwordx4 v[196:199], v5, s[8:11], s57 offen offset:0 sc1
    s_waitcnt vmcnt(16)
    v_mfma_f32_16x16x32_bf16 v[8:11], v[88:91], v[200:203], v[8:11]
    v_mfma_f32_16x16x32_bf16 v[24:27], v[92:95], v[200:203], v[24:27]
    v_mfma_f32_16x16x32_bf16 v[40:43], v[96:99], v[200:203], v[40:43]
    v_mfma_f32_16x16x32_bf16 v[56:59], v[100:103], v[200:203], v[56:59]
    buffer_load_dwordx4 v[200:203], v5, s[8:11], s54 offen offset:1024 sc1
    v_mfma_f32_16x16x32_bf16 v[12:15], v[88:91], v[204:207], v[12:15]
    v_mfma_f32_16x16x32_bf16 v[28:31], v[92:95], v[204:207], v[28:31]
    v_mfma_f32_16x16x32_bf16 v[44:47], v[96:99], v[204:207], v[44:47]
    v_mfma_f32_16x16x32_bf16 v[60:63], v[100:103], v[204:207], v[60:63]
    buffer_load_dwordx4 v[204:207], v5, s[8:11], s55 offen offset:1024 sc1
    v_mfma_f32_16x16x32_bf16 v[16:19], v[88:91], v[208:211], v[16:19]
    v_mfma_f32_16x16x32_bf16 v[32:35], v[92:95], v[208:211], v[32:35]
    v_mfma_f32_16x16x32_bf16 v[48:51], v[96:99], v[208:211], v[48:51]
    v_mfma_f32_16x16x32_bf16 v[64:67], v[100:103], v[208:211], v[64:67]
    buffer_load_dwordx4 v[208:211], v5, s[8:11], s56 offen offset:1024 sc1
    v_mfma_f32_16x16x32_bf16 v[20:23], v[88:91], v[212:215], v[20:23]
    v_mfma_f32_16x16x32_bf16 v[36:39], v[92:95], v[212:215], v[36:39]
    v_mfma_f32_16x16x32_bf16 v[52:55], v[96:99], v[212:215], v[52:55]
    v_mfma_f32_16x16x32_bf16 v[68:71], v[100:103], v[212:215], v[68:71]
    buffer_load_dwordx4 v[212:215], v5, s[8:11], s57 offen offset:1024 sc1
    s_waitcnt vmcnt(16)
    v_mfma_f32_16x16x32_bf16 v[8:11], v[104:107], v[216:219], v[8:11]
    v_mfma_f32_16x16x32_bf16 v[24:27], v[108:111], v[216:219], v[24:27]
    v_mfma_f32_16x16x32_bf16 v[40:43], v[112:115], v[216:219], v[40:43]
    v_mfma_f32_16x16x32_bf16 v[56:59], v[116:119], v[216:219], v[56:59]
    buffer_load_dwordx4 v[216:219], v5, s[8:11], s54 offen offset:2048 sc1
    v_mfma_f32_16x16x32_bf16 v[12:15], v[104:107], v[220:223], v[12:15]
    v_mfma_f32_16x16x32_bf16 v[28:31], v[108:111], v[220:223], v[28:31]
    v_mfma_f32_16x16x32_bf16 v[44:47], v[112:115], v[220:223], v[44:47]
    v_mfma_f32_16x16x32_bf16 v[60:63], v[116:119], v[220:223], v[60:63]
    buffer_load_dwordx4 v[220:223], v5, s[8:11], s55 offen offset:2048 sc1
    v_mfma_f32_16x16x32_bf16 v[16:19], v[104:107], v[224:227], v[16:19]
    v_mfma_f32_16x16x32_bf16 v[32:35], v[108:111], v[224:227], v[32:35]
    v_mfma_f32_16x16x32_bf16 v[48:51], v[112:115], v[224:227], v[48:51]
    v_mfma_f32_16x16x32_bf16 v[64:67], v[116:119], v[224:227], v[64:67]
    buffer_load_dwordx4 v[224:227], v5, s[8:11], s56 offen offset:2048 sc1
    v_mfma_f32_16x16x32_bf16 v[20:23], v[104:107], v[228:231], v[20:23]
    v_mfma_f32_16x16x32_bf16 v[36:39], v[108:111], v[228:231], v[36:39]
    v_mfma_f32_16x16x32_bf16 v[52:55], v[112:115], v[228:231], v[52:55]
    v_mfma_f32_16x16x32_bf16 v[68:71], v[116:119], v[228:231], v[68:71]
    buffer_load_dwordx4 v[228:231], v5, s[8:11], s57 offen offset:2048 sc1
    s_waitcnt vmcnt(12)
    v_mfma_f32_16x16x32_bf16 v[8:11], v[120:123], v[232:235], v[8:11]
    v_mfma_f32_16x16x32_bf16 v[24:27], v[124:127], v[232:235], v[24:27]
    v_mfma_f32_16x16x32_bf16 v[40:43], v[128:131], v[232:235], v[40:43]
    v_mfma_f32_16x16x32_bf16 v[56:59], v[132:135], v[232:235], v[56:59]
    v_mfma_f32_16x16x32_bf16 v[12:15], v[120:123], v[236:239], v[12:15]
    v_mfma_f32_16x16x32_bf16 v[28:31], v[124:127], v[236:239], v[28:31]
    v_mfma_f32_16x16x32_bf16 v[44:47], v[128:131], v[236:239], v[44:47]
    v_mfma_f32_16x16x32_bf16 v[60:63], v[132:135], v[236:239], v[60:63]
    v_mfma_f32_16x16x32_bf16 v[16:19], v[120:123], v[240:243], v[16:19]
    v_mfma_f32_16x16x32_bf16 v[32:35], v[124:127], v[240:243], v[32:35]
    v_mfma_f32_16x16x32_bf16 v[48:51], v[128:131], v[240:243], v[48:51]
    v_mfma_f32_16x16x32_bf16 v[64:67], v[132:135], v[240:243], v[64:67]
    v_mfma_f32_16x16x32_bf16 v[20:23], v[120:123], v[244:247], v[20:23]
    v_mfma_f32_16x16x32_bf16 v[36:39], v[124:127], v[244:247], v[36:39]
    v_mfma_f32_16x16x32_bf16 v[52:55], v[128:131], v[244:247], v[52:55]
    v_mfma_f32_16x16x32_bf16 v[68:71], v[132:135], v[244:247], v[68:71]
    s_waitcnt vmcnt(8)
    v_mfma_f32_16x16x32_bf16 v[8:11], v[136:139], v[184:187], v[8:11]
    v_mfma_f32_16x16x32_bf16 v[24:27], v[140:143], v[184:187], v[24:27]
    v_mfma_f32_16x16x32_bf16 v[40:43], v[144:147], v[184:187], v[40:43]
    v_mfma_f32_16x16x32_bf16 v[56:59], v[148:151], v[184:187], v[56:59]
    v_mfma_f32_16x16x32_bf16 v[12:15], v[136:139], v[188:191], v[12:15]
    v_mfma_f32_16x16x32_bf16 v[28:31], v[140:143], v[188:191], v[28:31]
    v_mfma_f32_16x16x32_bf16 v[44:47], v[144:147], v[188:191], v[44:47]
    v_mfma_f32_16x16x32_bf16 v[60:63], v[148:151], v[188:191], v[60:63]
    v_mfma_f32_16x16x32_bf16 v[16:19], v[136:139], v[192:195], v[16:19]
    v_mfma_f32_16x16x32_bf16 v[32:35], v[140:143], v[192:195], v[32:35]
    v_mfma_f32_16x16x32_bf16 v[48:51], v[144:147], v[192:195], v[48:51]
    v_mfma_f32_16x16x32_bf16 v[64:67], v[148:151], v[192:195], v[64:67]
    v_mfma_f32_16x16x32_bf16 v[20:23], v[136:139], v[196:199], v[20:23]
    v_mfma_f32_16x16x32_bf16 v[36:39], v[140:143], v[196:199], v[36:39]
    v_mfma_f32_16x16x32_bf16 v[52:55], v[144:147], v[196:199], v[52:55]
    v_mfma_f32_16x16x32_bf16 v[68:71], v[148:151], v[196:199], v[68:71]
    s_waitcnt vmcnt(4)
    v_mfma_f32_16x16x32_bf16 v[8:11], v[152:155], v[200:203], v[8:11]
    v_mfma_f32_16x16x32_bf16 v[24:27], v[156:159], v[200:203], v[24:27]
    v_mfma_f32_16x16x32_bf16 v[40:43], v[160:163], v[200:203], v[40:43]
    v_mfma_f32_16x16x32_bf16 v[56:59], v[164:167], v[200:203], v[56:59]
    v_mfma_f32_16x16x32_bf16 v[12:15], v[152:155], v[204:207], v[12:15]
    v_mfma_f32_16x16x32_bf16 v[28:31], v[156:159], v[204:207], v[28:31]
    v_mfma_f32_16x16x32_bf16 v[44:47], v[160:163], v[204:207], v[44:47]
    v_mfma_f32_16x16x32_bf16 v[60:63], v[164:167], v[204:207], v[60:63]
    v_mfma_f32_16x16x32_bf16 v[16:19], v[152:155], v[208:211], v[16:19]
    v_mfma_f32_16x16x32_bf16 v[32:35], v[156:159], v[208:211], v[32:35]
    v_mfma_f32_16x16x32_bf16 v[48:51], v[160:163], v[208:211], v[48:51]
    v_mfma_f32_16x16x32_bf16 v[64:67], v[164:167], v[208:211], v[64:67]
    v_mfma_f32_16x16x32_bf16 v[20:23], v[152:155], v[212:215], v[20:23]
    v_mfma_f32_16x16x32_bf16 v[36:39], v[156:159], v[212:215], v[36:39]
    v_mfma_f32_16x16x32_bf16 v[52:55], v[160:163], v[212:215], v[52:55]
    v_mfma_f32_16x16x32_bf16 v[68:71], v[164:167], v[212:215], v[68:71]
    s_waitcnt vmcnt(0)
    v_mfma_f32_16x16x32_bf16 v[8:11], v[168:171], v[216:219], v[8:11]
    v_mfma_f32_16x16x32_bf16 v[24:27], v[172:175], v[216:219], v[24:27]
    v_mfma_f32_16x16x32_bf16 v[40:43], v[176:179], v[216:219], v[40:43]
    v_mfma_f32_16x16x32_bf16 v[56:59], v[180:183], v[216:219], v[56:59]
    v_mfma_f32_16x16x32_bf16 v[12:15], v[168:171], v[220:223], v[12:15]
    v_mfma_f32_16x16x32_bf16 v[28:31], v[172:175], v[220:223], v[28:31]
    v_mfma_f32_16x16x32_bf16 v[44:47], v[176:179], v[220:223], v[44:47]
    v_mfma_f32_16x16x32_bf16 v[60:63], v[180:183], v[220:223], v[60:63]
    v_mfma_f32_16x16x32_bf16 v[16:19], v[168:171], v[224:227], v[16:19]
    ds_write_b128 v248, v[8:11] offset:0
    v_mfma_f32_16x16x32_bf16 v[32:35], v[172:175], v[224:227], v[32:35]
    ds_write_b128 v249, v[24:27] offset:1024
    v_mfma_f32_16x16x32_bf16 v[48:51], v[176:179], v[224:227], v[48:51]
    ds_write_b128 v250, v[40:43] offset:2048
    v_mfma_f32_16x16x32_bf16 v[64:67], v[180:183], v[224:227], v[64:67]
    ds_write_b128 v251, v[56:59] offset:3072
    v_mfma_f32_16x16x32_bf16 v[20:23], v[168:171], v[228:231], v[20:23]
    ds_write_b128 v248, v[12:15] offset:4096
    v_mfma_f32_16x16x32_bf16 v[36:39], v[172:175], v[228:231], v[36:39]
    ds_write_b128 v249, v[28:31] offset:5120
    v_mfma_f32_16x16x32_bf16 v[52:55], v[176:179], v[228:231], v[52:55]
    ds_write_b128 v250, v[44:47] offset:6144
    v_mfma_f32_16x16x32_bf16 v[68:71], v[180:183], v[228:231], v[68:71]
    ds_write_b128 v251, v[60:63] offset:7168
    s_nop 4
    ds_write_b128 v248, v[16:19] offset:8192
    ds_write_b128 v249, v[32:35] offset:9216
    ds_write_b128 v250, v[48:51] offset:10240
    ds_write_b128 v251, v[64:67] offset:11264
    ds_write_b128 v248, v[20:23] offset:12288
    ds_write_b128 v249, v[36:39] offset:13312
    ds_write_b128 v250, v[52:55] offset:14336
    ds_write_b128 v251, v[68:71] offset:15360
    s_waitcnt lgkmcnt(0)
    s_barrier
recurrent_scan__ssm_conv_h3__mixer_gmlp__prompt_kernel_end:
    s_endpgm
.section .rodata,"a"
.p2align 6
.amdhsa_kernel recurrent_scan__ssm_conv_h3__mixer_gmlp__prompt_kernel
  .amdhsa_next_free_vgpr 256
  .amdhsa_next_free_sgpr 102
  .amdhsa_accum_offset 256
  .amdhsa_group_segment_fixed_size 0
  .amdhsa_kernarg_size 112
  .amdhsa_user_sgpr_count 2
  .amdhsa_user_sgpr_kernarg_segment_ptr 1
  .amdhsa_system_sgpr_workgroup_id_x 1
  .amdhsa_float_denorm_mode_32 3
.end_amdhsa_kernel
.text
code_end:
```
